```python
import torch

def _softmax(x, axis=-1):
    return torch.softmax(x, dim=axis)
def _gelu(x):
    return torch.nn.functional.gelu(x, approximate="tanh")
def _silu(x):
    return torch.nn.functional.silu(x)
def _sigmoid(x):
    return torch.sigmoid(x)
def _layernorm(x, axis=-1, eps=1e-5):
    m = x.mean(dim=axis, keepdim=True)
    v = x.var(dim=axis, keepdim=True, unbiased=False)
    return (x - m) / torch.sqrt(v + eps)
def _scatter_add(tgt, idx, src, axis=0):
    return tgt.clone().index_add_(axis, idx, src)
def _segment_sum(src, seg, n):
    out = torch.zeros((n,) + src.shape[1:], dtype=src.dtype)
    return out.index_add_(0, seg, src)
def _pad(x, pw):
    flat = tuple(v for pair in reversed(pw) for v in pair)
    return torch.nn.functional.pad(x, flat)

kernel_name = 'standalone__molecular_angular_gemnet__graph'

def setup_inputs():

    _w = (lambda a: (lambda t: t.to(torch.bfloat16) if t.is_floating_point() else t)(torch.as_tensor(a)))
    N, deg, De, L = 50000, 16, 4, 1
    E = N * deg
    T = E * deg
    NR = 8
    dist = torch.rand(E).to(float)
    angle = (torch.rand(T) * torch.pi).to(float)
    centers = torch.linspace(0.0, 1.0, NR).to(float)
    ang_freq = torch.arange(1, L + 1).to(float)
    return {
        "m": _w((lambda *s: torch.randn(*s, dtype=torch.bfloat16) * 0.05)(E, De)),
        "idx_in": _w((lambda lo, hi, *s: torch.randint(lo, hi, s))(0, E, T).to(torch.int64)),
        "idx_out": _w((lambda lo, hi, *s: torch.randint(lo, hi, s))(0, E, T).to(torch.int64)),
        "dist": _w(dist),
        "angle": _w(angle),
        "centers": _w(centers),
        "ang_freq": _w(ang_freq),
        "w_rbf": _w((lambda *s: torch.randn(*s, dtype=torch.bfloat16) * 0.4)(NR, De)),
        "w_sbf": _w((lambda *s: torch.randn(*s, dtype=torch.bfloat16) * 0.4)(NR * L, De)),
        "w_down": _w((lambda *s: torch.randn(*s, dtype=torch.bfloat16) * 0.4)(De, De)),
        "w_up": _w((lambda *s: torch.randn(*s, dtype=torch.bfloat16) * 0.4)(De, De)),
    }

def reference(m, idx_in, idx_out, dist, angle, centers, ang_freq, w_rbf, w_sbf, w_down, w_up):
    E, De = m.shape[0], m.shape[1]
    NR = centers.shape[0]
    L = ang_freq.shape[0]
    rbf = torch.exp(-10.0 * (dist[:, None] - centers[None, :]) ** 2)
    cbf = torch.cos(ang_freq[None, :] * angle[:, None])
    rbf_t = rbf[idx_out]
    sbf = torch.reshape(rbf_t[:, :, None] * cbf[:, None, :], (-1, NR * L))
    x = (m[idx_in] @ w_down) * (sbf @ w_sbf)
    agg = _segment_sum(x, idx_out, E)
    return m + (agg @ w_up) * (rbf @ w_rbf)
```

```asm
; @launch kernel=standalone__molecular_angular_gemnet__graph_kernel grid=(256,1,1) block=(1024,1,1) lds=163072
.amdgcn_target "amdgcn-amd-amdhsa--gfx950"
.text
.globl standalone__molecular_angular_gemnet__graph_kernel
.p2align 8
.type standalone__molecular_angular_gemnet__graph_kernel,@function
standalone__molecular_angular_gemnet__graph_kernel:
    s_load_dwordx2 s[16:17], s[0:1], 8
    s_load_dwordx2 s[20:21], s[0:1], 16
    s_load_dwordx2 s[24:25], s[0:1], 32
    s_cmpk_ge_u32 s2, 256
    s_cbranch_scc1 f_done
    s_getpc_b64 s[72:73]
f_pc0:
    s_mov_b32 s74, c_fallback - f_pc0
    s_mov_b32 s75, 0x00020000
    v_lshlrev_b32 v126, 7, v0
    buffer_load_dword v126, v126, s[72:75], 0 offen
    v_lshlrev_b32 v1, 4, v0
    v_lshlrev_b32 v2, 3, v0
    s_mov_b32 s18, 51200000
    s_mov_b32 s19, 0x00020000
    s_mov_b64 s[22:23], s[18:19]
    s_lshr_b32 s26, s18, 1
    s_mov_b32 s27, s19
    s_lshl_b32 s40, s2, 14
    s_add_u32 s41, s40, 4194304
    s_add_u32 s42, s40, 8388608
    s_load_dwordx2 s[92:93], s[0:1], 48
    s_load_dwordx2 s[4:5], s[0:1], 96
    s_load_dwordx2 s[8:9], s[0:1], 104
    v_cmp_gt_u32 vcc, 212, v0
    v_readfirstlane_b32 s3, v0
    v_and_b32 v5, 0x3f0, v1
    v_bfrev_b32 v3, 2
    s_mov_b64 s[36:37], vcc
    s_mov_b64 exec, vcc
    v_lshlrev_b32 v3, 2, v0
    s_mov_b64 exec, -1
    v_mov_b32 v10, 0
    v_mov_b32 v11, 0
    v_mov_b32 v12, 0
    v_mov_b32 v13, 0
    ds_write_b128 v5, v[10:13] offset:48384
    ds_write_b128 v5, v[10:13] offset:512
    ds_write_b128 v10, v[10:13] offset:288
    ds_write_b128 v10, v[10:13] offset:304
    s_lshr_b32 s3, s3, 6
    s_mov_b32 s6, 256
    s_mov_b32 s7, 0x00020000
    s_mov_b32 s10, 236978176
    s_mov_b32 s11, 0x00020000
    s_mov_b32 s14, 0
    s_mov_b32 s15, 0x00020000
    s_mul_i32 s43, s2, 848
    s_add_u32 s43, s43, 50331648
    s_lshr_b32 s45, s3, 3
    s_mov_b32 s65, 0
    s_mov_b64 s[60:61], 0
    s_mov_b64 s[62:63], 0
    s_mov_b32 s94, 0
    s_lshr_b32 s66, s2, 3
    s_mul_i32 s66, s66, 3
    s_lshr_b32 s66, s66, 5
    s_cmp_eq_u32 s3, 12
    s_cselect_b32 s66, s66, 99
    s_waitcnt lgkmcnt(0)
    s_load_dword s33, s[92:93], 0
    s_sub_u32 s31, 0, s8
    s_and_b32 s31, s31, 2097151
    s_add_u32 s8, s8, s31
    s_addc_u32 s9, s9, 0
    s_mov_b32 s12, s8
    s_mov_b32 s13, s9
    s_and_b32 s29, s2, 56
    s_or_b32 s29, s29, s3
    s_cmp_lg_u32 s29, 0
    s_cbranch_scc1 a_nops
    s_lshr_b32 s38, s2, 6
    s_lshl_b32 s38, s38, 3
    s_and_b32 s31, s2, 7
    s_or_b32 s38, s38, s31
    s_mul_i32 s39, s38, 6291456
    s_bfe_u32 s31, s38, 0x10003
    s_lshl_b32 s31, s31, 13
    s_add_u32 s39, s39, s31
    s_add_u32 s39, s39, 10469376
    s_xor_b32 s31, s39, 0x2000
    buffer_store_dwordx2 v[10:11], v2, s[8:11], s39 offen sc1
    buffer_store_dwordx2 v[10:11], v2, s[8:11], s31 offen sc1
    s_load_dwordx2 s[68:69], s[0:1], 0
    s_load_dwordx2 s[72:73], s[0:1], 72
    s_mov_b32 s70, 6400000
    s_mov_b32 s71, 0x00020000
    s_mul_i32 s31, s38, 199680
    s_waitcnt lgkmcnt(0)
    s_load_dwordx8 s[76:83], s[72:73], 0
    buffer_load_dwordx4 v[56:59], v1, s[68:71], s31 offen
    buffer_load_dwordx4 v[60:63], v1, s[68:71], s31 offen offset:1024
    buffer_load_dwordx4 v[84:87], v1, s[68:71], s31 offen offset:2048
    buffer_load_dwordx4 v[88:91], v1, s[68:71], s31 offen offset:3072
a_nops:
    s_lshr_b32 s32, s40, 1
    buffer_load_dwordx4 v[20:23], v1, s[16:19], s40 offen nt
    buffer_load_dwordx4 v[34:37], v1, s[20:23], s40 offen nt
    buffer_load_dwordx2 v[48:49], v2, s[24:27], s32 offen nt
    s_add_u32 s40, s40, 12582912
    s_barrier
    v_mov_b32 v6, 6
    v_and_b32 v83, 0x1fff, v1
    v_lshrrev_b32 v10, 9, v0
    v_mul_u32_u24 v10, 40800, v10
    v_add_u32 v8, v83, v10
    v_sub_u32 v105, v83, v10
    v_add_u32 v8, 50432, v8
    v_add_u32 v105, 91232, v105
    v_bfe_u32 v10, v0, 5, 1
    v_mul_u32_u24 v97, 40800, v10
    v_mov_b32 v47, 0
    v_mov_b32 v4, 0
    v_mov_b32 v9, 0
    v_mov_b32 v55, 0
    v_mov_b32 v69, 0
    s_mul_i32 s31, s2, 1311
    s_lshr_b32 s31, s31, 15
    s_mul_i32 s30, s2, 81920
    s_xor_b32 s32, s31, s45
    s_and_b32 s32, s32, 1
    s_lshl_b32 s32, s32, 13
    s_mul_i32 s31, s31, 49152
    s_add_u32 s30, s30, s31
    s_add_u32 s30, s30, s32
    s_add_u32 s31, s60, 0
    s_mov_b32 s14, s61
    buffer_store_dwordx4 v[106:109], v83, s[12:15], s31 offen sc1
    s_add_u32 s31, s62, 16384
    s_mov_b32 s14, s63
    buffer_store_dwordx4 v[110:113], v83, s[12:15], s31 offen sc1
    s_lshr_b32 s32, s41, 1
    buffer_load_dwordx4 v[24:27], v1, s[16:19], s41 offen nt
    buffer_load_dwordx4 v[38:41], v1, s[20:23], s41 offen nt
    buffer_load_dwordx2 v[50:51], v2, s[24:27], s32 offen nt
    s_add_u32 s41, s41, 12582912
    s_add_u32 s31, s60, 32768
    s_mov_b32 s14, s61
    buffer_store_dwordx4 v[114:117], v83, s[12:15], s31 offen sc1
    s_add_u32 s31, s62, 49152
    s_mov_b32 s14, s63
    buffer_store_dwordx4 v[118:121], v83, s[12:15], s31 offen sc1
    s_add_u32 s31, s60, 65536
    s_mov_b32 s14, s61
    buffer_store_dwordx4 v[122:125], v83, s[12:15], s31 offen sc1
    s_waitcnt lgkmcnt(0)
    s_lshl_b32 s33, s33, 16
    v_mov_b32 v7, s33
    s_branch a_skipro
a_loop:
    s_cmp_lg_u32 s66, -1
    s_cbranch_scc1 a_nosigb
    v_mov_b32 v10, 1
    v_mov_b32 v11, 128
    s_mov_b64 exec, 1
    buffer_atomic_add v10, v11, s[4:7], 0 offen sc1
    s_mov_b64 exec, -1
a_nosigb:
    ds_read_b128 v[106:109], v8 offset:0
    ds_read_b128 v[110:113], v105 offset:8160
    ds_read_b128 v[114:117], v8 offset:16320
    ds_read_b128 v[118:121], v105 offset:24480
    ds_read_b128 v[122:125], v8 offset:32640
a_skipro:
    s_lshr_b32 s32, s42, 1
    buffer_load_dwordx4 v[28:31], v1, s[16:19], s42 offen nt
    buffer_load_dwordx4 v[42:45], v1, s[20:23], s42 offen nt
    buffer_load_dwordx2 v[52:53], v2, s[24:27], s32 offen nt
    s_add_u32 s42, s42, 12582912
    s_lshr_b32 s32, s43, 1
    v_lshrrev_b32 v54, 1, v3
    buffer_load_dword v32, v3, s[16:19], s43 offen nt
    buffer_load_dword v46, v3, s[20:23], s43 offen nt
    buffer_load_ushort v54, v54, s[24:27], s32 offen nt
    s_add_u32 s43, s43, 217088
    s_cmp_lg_u32 s94, 0
    s_cbranch_scc1 a_nofirst
    s_cmp_lt_u32 s3, 8
    s_cbranch_scc1 a_noclr
    s_lshl_b32 s31, s2, 13
    s_add_u32 s31, s31, 234881024
    v_mov_b32 v10, 0
    buffer_store_dwordx4 v[10:13], v83, s[8:11], s31 offen sc1
    s_branch a_notab
a_noclr:
    s_cmp_lg_u32 s29, 0
    s_cbranch_scc1 a_noprobe
    s_waitcnt vmcnt(17)
    s_add_u32 s54, s8, s39
    s_addc_u32 s55, s9, 0
    s_xor_b32 s56, s54, 0x2000
    s_mov_b32 s57, s55
    s_load_dword s58, s[54:55], 384
    s_mov_b32 s31, -1
    s_mov_b32 s32, -1
    s_waitcnt lgkmcnt(0)
    s_memtime s[48:49]
    s_waitcnt lgkmcnt(0)
    s_load_dword s58, s[54:55], 0
    s_waitcnt lgkmcnt(0)
    s_memtime s[50:51]
    s_waitcnt lgkmcnt(0)
    s_load_dword s58, s[56:57], 0
    s_sub_u32 s52, s50, s48
    s_min_u32 s31, s31, s52
    s_waitcnt lgkmcnt(0)
    s_memtime s[48:49]
    s_waitcnt lgkmcnt(0)
    s_sub_u32 s52, s48, s50
    s_min_u32 s32, s32, s52
    s_load_dword s58, s[54:55], 128
    s_waitcnt lgkmcnt(0)
    s_memtime s[50:51]
    s_waitcnt lgkmcnt(0)
    s_load_dword s58, s[56:57], 128
    s_sub_u32 s52, s50, s48
    s_min_u32 s31, s31, s52
    s_waitcnt lgkmcnt(0)
    s_memtime s[48:49]
    s_waitcnt lgkmcnt(0)
    s_sub_u32 s52, s48, s50
    s_min_u32 s32, s32, s52
    s_load_dword s58, s[54:55], 256
    s_waitcnt lgkmcnt(0)
    s_memtime s[50:51]
    s_waitcnt lgkmcnt(0)
    s_load_dword s58, s[56:57], 256
    s_sub_u32 s52, s50, s48
    s_min_u32 s31, s31, s52
    s_waitcnt lgkmcnt(0)
    s_memtime s[48:49]
    s_waitcnt lgkmcnt(0)
    s_sub_u32 s52, s48, s50
    s_min_u32 s32, s32, s52
    s_cmp_lt_u32 s32, s31
    s_cselect_b32 s44, 1, 0
    s_lshr_b32 s31, s39, 13
    s_xor_b32 s44, s44, s31
    s_lshr_b32 s31, s39, 21
    s_xor_b32 s44, s44, s31
    s_lshr_b32 s31, s2, 2
    s_xor_b32 s44, s44, s31
    s_and_b32 s44, s44, 1
    s_getreg_b32 s31, hwreg(HW_REG_XCC_ID)
    s_xor_b32 s32, s31, s2
    s_lshr_b32 s32, s32, 2
    s_xor_b32 s44, s44, s32
    s_and_b32 s44, s44, 1
    s_sub_u32 s31, s31, s2
    s_and_b32 s31, s31, 7
    s_lshl_b32 s31, s31, 1
    s_or_b32 s44, s44, s31
    v_bfe_i32 v12, v0, 0, 1
    v_bfe_i32 v13, v0, 1, 1
    v_and_b32 v12, 0x02020202, v12
    v_add_u32 v12, 0x05040100, v12
    v_mov_b32 v10, s76
    v_bfi_b32 v10, v13, s77, v10
    v_mov_b32 v11, s78
    v_bfi_b32 v11, v13, s79, v11
    v_perm_b32 v64, v11, v10, v12
    v_mov_b32 v10, s80
    v_bfi_b32 v10, v13, s81, v10
    v_mov_b32 v11, s82
    v_bfi_b32 v11, v13, s83, v11
    v_perm_b32 v65, v11, v10, v12
    v_mov_b32 v10, 0
    s_nop 0
    v_mfma_f32_4x4x4_16b_bf16 v[70:73], v[64:65], v[56:57], 0
    v_mfma_f32_4x4x4_16b_bf16 v[74:77], v[64:65], v[58:59], 0
    s_nop 3
    v_and_b32 v70, 0x7fffffff, v70
    v_and_b32 v71, 0x7fffffff, v71
    v_max3_u32 v10, v70, v71, v10
    v_and_b32 v72, 0x7fffffff, v72
    v_and_b32 v73, 0x7fffffff, v73
    v_max3_u32 v10, v72, v73, v10
    v_and_b32 v74, 0x7fffffff, v74
    v_and_b32 v75, 0x7fffffff, v75
    v_max3_u32 v10, v74, v75, v10
    v_and_b32 v76, 0x7fffffff, v76
    v_and_b32 v77, 0x7fffffff, v77
    v_max3_u32 v10, v76, v77, v10
    v_mfma_f32_4x4x4_16b_bf16 v[70:73], v[64:65], v[60:61], 0
    v_mfma_f32_4x4x4_16b_bf16 v[74:77], v[64:65], v[62:63], 0
    s_nop 3
    v_and_b32 v70, 0x7fffffff, v70
    v_and_b32 v71, 0x7fffffff, v71
    v_max3_u32 v10, v70, v71, v10
    v_and_b32 v72, 0x7fffffff, v72
    v_and_b32 v73, 0x7fffffff, v73
    v_max3_u32 v10, v72, v73, v10
    v_and_b32 v74, 0x7fffffff, v74
    v_and_b32 v75, 0x7fffffff, v75
    v_max3_u32 v10, v74, v75, v10
    v_and_b32 v76, 0x7fffffff, v76
    v_and_b32 v77, 0x7fffffff, v77
    v_max3_u32 v10, v76, v77, v10
    v_mfma_f32_4x4x4_16b_bf16 v[70:73], v[64:65], v[84:85], 0
    v_mfma_f32_4x4x4_16b_bf16 v[74:77], v[64:65], v[86:87], 0
    s_nop 3
    v_and_b32 v70, 0x7fffffff, v70
    v_and_b32 v71, 0x7fffffff, v71
    v_max3_u32 v10, v70, v71, v10
    v_and_b32 v72, 0x7fffffff, v72
    v_and_b32 v73, 0x7fffffff, v73
    v_max3_u32 v10, v72, v73, v10
    v_and_b32 v74, 0x7fffffff, v74
    v_and_b32 v75, 0x7fffffff, v75
    v_max3_u32 v10, v74, v75, v10
    v_and_b32 v76, 0x7fffffff, v76
    v_and_b32 v77, 0x7fffffff, v77
    v_max3_u32 v10, v76, v77, v10
    v_mfma_f32_4x4x4_16b_bf16 v[70:73], v[64:65], v[88:89], 0
    v_mfma_f32_4x4x4_16b_bf16 v[74:77], v[64:65], v[90:91], 0
    s_nop 3
    v_and_b32 v70, 0x7fffffff, v70
    v_and_b32 v71, 0x7fffffff, v71
    v_max3_u32 v10, v70, v71, v10
    v_and_b32 v72, 0x7fffffff, v72
    v_and_b32 v73, 0x7fffffff, v73
    v_max3_u32 v10, v72, v73, v10
    v_and_b32 v74, 0x7fffffff, v74
    v_and_b32 v75, 0x7fffffff, v75
    v_max3_u32 v10, v74, v75, v10
    v_and_b32 v76, 0x7fffffff, v76
    v_and_b32 v77, 0x7fffffff, v77
    v_max3_u32 v10, v76, v77, v10
    s_nop 1
    v_max_u32_dpp v10, v10, v10 row_shr:1 row_mask:0xf bank_mask:0xf
    s_nop 1
    v_max_u32_dpp v10, v10, v10 row_shr:2 row_mask:0xf bank_mask:0xf
    s_nop 1
    v_max_u32_dpp v10, v10, v10 row_shr:4 row_mask:0xf bank_mask:0xf
    s_nop 1
    v_max_u32_dpp v10, v10, v10 row_shr:8 row_mask:0xf bank_mask:0xf
    s_nop 1
    v_max_u32_dpp v10, v10, v10 row_bcast:15 row_mask:0xa bank_mask:0xf
    s_nop 1
    v_max_u32_dpp v10, v10, v10 row_bcast:31 row_mask:0xc bank_mask:0xf
    s_nop 0
    v_readlane_b32 s32, v10, 63
    s_lshl_b32 s31, s38, 2
    s_or_b32 s44, s44, 256
    s_and_b32 s32, s32, -16
    s_or_b32 s44, s44, s32
    v_mov_b32 v10, 0
    v_mov_b32 v11, s44
    s_mov_b64 exec, 1
    buffer_store_dword v11, v10, s[4:7], s31 offen sc1
    s_mov_b64 exec, -1
a_noprobe:
    s_cmp_lg_u32 s3, 1
    s_cbranch_scc1 a_notab
    s_load_dwordx8 s[48:55], s[0:1], 56
    s_load_dwordx2 s[56:57], s[0:1], 40
    s_waitcnt lgkmcnt(0)
    s_load_dwordx16 s[68:83], s[48:49], 0
    s_load_dwordx8 s[84:91], s[54:55], 0
    s_load_dwordx4 s[56:59], s[56:57], 0
    v_bfe_i32 v12, v0, 0, 1
    v_bfe_i32 v13, v0, 1, 1
    v_and_b32 v12, 0x02020202, v12
    v_add_u32 v12, 0x05040100, v12
    s_waitcnt lgkmcnt(0)
    v_mov_b32 v10, s68
    v_bfi_b32 v10, v13, s69, v10
    v_mov_b32 v11, s70
    v_bfi_b32 v11, v13, s71, v11
    v_perm_b32 v56, v11, v10, v12
    v_mov_b32 v10, s72
    v_bfi_b32 v10, v13, s73, v10
    v_mov_b32 v11, s74
    v_bfi_b32 v11, v13, s75, v11
    v_perm_b32 v57, v11, v10, v12
    v_mov_b32 v10, s76
    v_bfi_b32 v10, v13, s77, v10
    v_mov_b32 v11, s78
    v_bfi_b32 v11, v13, s79, v11
    v_perm_b32 v58, v11, v10, v12
    v_mov_b32 v10, s80
    v_bfi_b32 v10, v13, s81, v10
    v_mov_b32 v11, s82
    v_bfi_b32 v11, v13, s83, v11
    v_perm_b32 v59, v11, v10, v12
    v_mov_b32 v10, s84
    v_bfi_b32 v10, v13, s85, v10
    v_mov_b32 v11, s86
    v_bfi_b32 v11, v13, s87, v11
    v_perm_b32 v64, v11, v10, v12
    v_mov_b32 v10, s88
    v_bfi_b32 v10, v13, s89, v10
    v_mov_b32 v11, s90
    v_bfi_b32 v11, v13, s91, v11
    v_perm_b32 v65, v11, v10, v12
    s_load_dwordx16 s[68:83], s[50:51], 0
    s_load_dwordx8 s[84:91], s[52:53], 0
    s_waitcnt lgkmcnt(0)
    v_mov_b32 v10, s68
    v_bfi_b32 v10, v13, s69, v10
    v_mov_b32 v11, s70
    v_bfi_b32 v11, v13, s71, v11
    v_perm_b32 v60, v11, v10, v12
    v_mov_b32 v10, s72
    v_bfi_b32 v10, v13, s73, v10
    v_mov_b32 v11, s74
    v_bfi_b32 v11, v13, s75, v11
    v_perm_b32 v61, v11, v10, v12
    v_mov_b32 v10, s76
    v_bfi_b32 v10, v13, s77, v10
    v_mov_b32 v11, s78
    v_bfi_b32 v11, v13, s79, v11
    v_perm_b32 v62, v11, v10, v12
    v_mov_b32 v10, s80
    v_bfi_b32 v10, v13, s81, v10
    v_mov_b32 v11, s82
    v_bfi_b32 v11, v13, s83, v11
    v_perm_b32 v63, v11, v10, v12
    v_mov_b32 v10, s84
    v_bfi_b32 v10, v13, s85, v10
    v_mov_b32 v11, s86
    v_bfi_b32 v11, v13, s87, v11
    v_perm_b32 v66, v11, v10, v12
    v_mov_b32 v10, s88
    v_bfi_b32 v10, v13, s89, v10
    v_mov_b32 v11, s90
    v_bfi_b32 v11, v13, s91, v11
    v_perm_b32 v67, v11, v10, v12
    v_lshlrev_b32 v84, 16, s56
    v_mov_b32 v85, 0xffff0000
    v_and_b32 v85, s56, v85
    v_lshlrev_b32 v86, 16, s57
    v_mov_b32 v87, 0xffff0000
    v_and_b32 v87, s57, v87
    v_lshlrev_b32 v88, 16, s58
    v_mov_b32 v89, 0xffff0000
    v_and_b32 v89, s58, v89
    v_lshlrev_b32 v90, 16, s59
    v_mov_b32 v91, 0xffff0000
    v_and_b32 v91, s59, v91
    v_lshlrev_b32 v10, 2, v5
    s_mov_b64 exec, 15
    ds_write_b128 v10, v[56:59] offset:0
    ds_write_b128 v10, v[60:63] offset:16
    ds_write_b128 v10, v[64:67] offset:32
    s_mov_b64 exec, 1
    ds_write_b128 v10, v[84:87] offset:256
    ds_write_b128 v10, v[88:91] offset:272
    s_mov_b64 exec, -1
a_notab:
a_nofirst:
    s_waitcnt vmcnt(14)
    v_lshrrev_b32 v70, 4, v20
    v_lshrrev_b32 v56, 8, v20
    v_and_b32 v70, 0x3fc, v70
    v_bfi_b32 v56, 63, v20, v56
    v_lshl_add_u32 v56, v56, 20, v34
    v_alignbit_b32 v56, v56, v56, 30
    v_lshrrev_b32 v71, 4, v21
    v_lshrrev_b32 v57, 8, v21
    v_and_b32 v71, 0x3fc, v71
    v_bfi_b32 v57, 63, v21, v57
    v_lshl_add_u32 v57, v57, 20, v35
    v_alignbit_b32 v57, v57, v57, 30
    v_lshrrev_b32 v72, 4, v22
    v_lshrrev_b32 v58, 8, v22
    v_and_b32 v72, 0x3fc, v72
    v_bfi_b32 v58, 63, v22, v58
    v_lshl_add_u32 v58, v58, 20, v36
    v_alignbit_b32 v58, v58, v58, 30
    v_lshrrev_b32 v73, 4, v23
    v_lshrrev_b32 v59, 8, v23
    v_and_b32 v73, 0x3fc, v73
    v_bfi_b32 v59, 63, v23, v59
    v_lshl_add_u32 v59, v59, 20, v37
    v_alignbit_b32 v59, v59, v59, 30
    s_waitcnt lgkmcnt(0)
    ds_add_rtn_u32 v84, v70, v6 offset:48384
    ds_add_rtn_u32 v85, v71, v6 offset:48384
    ds_add_rtn_u32 v86, v72, v6 offset:48384
    ds_add_rtn_u32 v87, v73, v6 offset:48384
    v_lshlrev_b32 v10, 16, v48
    v_and_b32 v11, 0xffff0000, v48
    v_lshlrev_b32 v12, 16, v49
    v_and_b32 v13, 0xffff0000, v49
    v_mul_f32 v10, v7, v10
    v_mul_f32 v11, v7, v11
    v_mul_f32 v12, v7, v12
    v_mul_f32 v13, v7, v13
    v_cvt_pk_bf16_f32 v10, 0, v10
    v_cvt_pk_bf16_f32 v11, 0, v11
    v_cvt_pk_bf16_f32 v12, 0, v12
    v_cvt_pk_bf16_f32 v13, 0, v13
    v_mul_f32 v14, 0x3e22f900, v10
    v_mul_f32 v15, 0x3e22f900, v11
    v_mul_f32 v16, 0x3e22f900, v12
    v_mul_f32 v17, 0x3e22f900, v13
    v_fract_f32 v14, v14
    v_fract_f32 v15, v15
    v_fract_f32 v16, v16
    v_fract_f32 v17, v17
    v_fmamk_f32 v10, v10, 0x36036e4e, v14
    v_fmamk_f32 v11, v11, 0x36036e4e, v15
    v_fmamk_f32 v12, v12, 0x36036e4e, v16
    v_fmamk_f32 v13, v13, 0x36036e4e, v17
    v_cos_f32 v10, v10
    v_cos_f32 v11, v11
    v_cos_f32 v12, v12
    v_cos_f32 v13, v13
    s_nop 0
    v_cvt_pk_bf16_f32 v10, 0, v10
    v_cvt_pk_bf16_f32 v11, 0, v11
    v_cvt_pk_bf16_f32 v12, 0, v12
    v_cvt_pk_bf16_f32 v13, 0, v13
    v_cvt_pkrtz_f16_f32 v98, v10, v11
    v_cvt_pkrtz_f16_f32 v99, v12, v13
    v_pk_add_f16 v47, v47, v98
    v_pk_add_f16 v47, v47, v99
    s_waitcnt vmcnt(9)
    v_lshrrev_b32 v74, 4, v24
    v_lshrrev_b32 v60, 8, v24
    v_and_b32 v74, 0x3fc, v74
    v_bfi_b32 v60, 63, v24, v60
    v_lshl_add_u32 v60, v60, 20, v38
    v_alignbit_b32 v60, v60, v60, 30
    v_lshrrev_b32 v75, 4, v25
    v_lshrrev_b32 v61, 8, v25
    v_and_b32 v75, 0x3fc, v75
    v_bfi_b32 v61, 63, v25, v61
    v_lshl_add_u32 v61, v61, 20, v39
    v_alignbit_b32 v61, v61, v61, 30
    v_lshrrev_b32 v76, 4, v26
    v_lshrrev_b32 v62, 8, v26
    v_and_b32 v76, 0x3fc, v76
    v_bfi_b32 v62, 63, v26, v62
    v_lshl_add_u32 v62, v62, 20, v40
    v_alignbit_b32 v62, v62, v62, 30
    v_lshrrev_b32 v77, 4, v27
    v_lshrrev_b32 v63, 8, v27
    v_and_b32 v77, 0x3fc, v77
    v_bfi_b32 v63, 63, v27, v63
    v_lshl_add_u32 v63, v63, 20, v41
    v_alignbit_b32 v63, v63, v63, 30
    ds_add_rtn_u32 v88, v74, v6 offset:48384
    ds_add_rtn_u32 v89, v75, v6 offset:48384
    ds_add_rtn_u32 v90, v76, v6 offset:48384
    ds_add_rtn_u32 v91, v77, v6 offset:48384
    v_lshlrev_b32 v10, 16, v50
    v_and_b32 v11, 0xffff0000, v50
    v_lshlrev_b32 v12, 16, v51
    v_and_b32 v13, 0xffff0000, v51
    v_mul_f32 v10, v7, v10
    v_mul_f32 v11, v7, v11
    v_mul_f32 v12, v7, v12
    v_mul_f32 v13, v7, v13
    v_cvt_pk_bf16_f32 v10, 0, v10
    v_cvt_pk_bf16_f32 v11, 0, v11
    v_cvt_pk_bf16_f32 v12, 0, v12
    v_cvt_pk_bf16_f32 v13, 0, v13
    v_mul_f32 v14, 0x3e22f900, v10
    v_mul_f32 v15, 0x3e22f900, v11
    v_mul_f32 v16, 0x3e22f900, v12
    v_mul_f32 v17, 0x3e22f900, v13
    v_fract_f32 v14, v14
    v_fract_f32 v15, v15
    v_fract_f32 v16, v16
    v_fract_f32 v17, v17
    v_fmamk_f32 v10, v10, 0x36036e4e, v14
    v_fmamk_f32 v11, v11, 0x36036e4e, v15
    v_fmamk_f32 v12, v12, 0x36036e4e, v16
    v_fmamk_f32 v13, v13, 0x36036e4e, v17
    v_cos_f32 v10, v10
    v_cos_f32 v11, v11
    v_cos_f32 v12, v12
    v_cos_f32 v13, v13
    s_nop 0
    v_cvt_pk_bf16_f32 v10, 0, v10
    v_cvt_pk_bf16_f32 v11, 0, v11
    v_cvt_pk_bf16_f32 v12, 0, v12
    v_cvt_pk_bf16_f32 v13, 0, v13
    v_cvt_pkrtz_f16_f32 v100, v10, v11
    v_cvt_pkrtz_f16_f32 v101, v12, v13
    v_pk_add_f16 v47, v47, v100
    v_pk_add_f16 v47, v47, v101
    s_waitcnt vmcnt(3)
    v_lshrrev_b32 v78, 4, v28
    v_lshrrev_b32 v64, 8, v28
    v_and_b32 v78, 0x3fc, v78
    v_bfi_b32 v64, 63, v28, v64
    v_lshl_add_u32 v64, v64, 20, v42
    v_alignbit_b32 v64, v64, v64, 30
    v_lshrrev_b32 v79, 4, v29
    v_lshrrev_b32 v65, 8, v29
    v_and_b32 v79, 0x3fc, v79
    v_bfi_b32 v65, 63, v29, v65
    v_lshl_add_u32 v65, v65, 20, v43
    v_alignbit_b32 v65, v65, v65, 30
    v_lshrrev_b32 v80, 4, v30
    v_lshrrev_b32 v66, 8, v30
    v_and_b32 v80, 0x3fc, v80
    v_bfi_b32 v66, 63, v30, v66
    v_lshl_add_u32 v66, v66, 20, v44
    v_alignbit_b32 v66, v66, v66, 30
    v_lshrrev_b32 v81, 4, v31
    v_lshrrev_b32 v67, 8, v31
    v_and_b32 v81, 0x3fc, v81
    v_bfi_b32 v67, 63, v31, v67
    v_lshl_add_u32 v67, v67, 20, v45
    v_alignbit_b32 v67, v67, v67, 30
    ds_add_rtn_u32 v92, v78, v6 offset:48384
    ds_add_rtn_u32 v93, v79, v6 offset:48384
    ds_add_rtn_u32 v94, v80, v6 offset:48384
    ds_add_rtn_u32 v95, v81, v6 offset:48384
    v_lshlrev_b32 v10, 16, v52
    v_and_b32 v11, 0xffff0000, v52
    v_lshlrev_b32 v12, 16, v53
    v_and_b32 v13, 0xffff0000, v53
    v_mul_f32 v10, v7, v10
    v_mul_f32 v11, v7, v11
    v_mul_f32 v12, v7, v12
    v_mul_f32 v13, v7, v13
    v_cvt_pk_bf16_f32 v10, 0, v10
    v_cvt_pk_bf16_f32 v11, 0, v11
    v_cvt_pk_bf16_f32 v12, 0, v12
    v_cvt_pk_bf16_f32 v13, 0, v13
    v_mul_f32 v14, 0x3e22f900, v10
    v_mul_f32 v15, 0x3e22f900, v11
    v_mul_f32 v16, 0x3e22f900, v12
    v_mul_f32 v17, 0x3e22f900, v13
    v_fract_f32 v14, v14
    v_fract_f32 v15, v15
    v_fract_f32 v16, v16
    v_fract_f32 v17, v17
    v_fmamk_f32 v10, v10, 0x36036e4e, v14
    v_fmamk_f32 v11, v11, 0x36036e4e, v15
    v_fmamk_f32 v12, v12, 0x36036e4e, v16
    v_fmamk_f32 v13, v13, 0x36036e4e, v17
    v_cos_f32 v10, v10
    v_cos_f32 v11, v11
    v_cos_f32 v12, v12
    v_cos_f32 v13, v13
    s_nop 0
    v_cvt_pk_bf16_f32 v10, 0, v10
    v_cvt_pk_bf16_f32 v11, 0, v11
    v_cvt_pk_bf16_f32 v12, 0, v12
    v_cvt_pk_bf16_f32 v13, 0, v13
    v_cvt_pkrtz_f16_f32 v102, v10, v11
    v_cvt_pkrtz_f16_f32 v103, v12, v13
    v_pk_add_f16 v47, v47, v102
    v_pk_add_f16 v47, v47, v103
    s_waitcnt vmcnt(0)
    s_mov_b64 exec, s[36:37]
    s_cbranch_execz a_s13al
    v_lshrrev_b32 v82, 4, v32
    v_lshrrev_b32 v68, 8, v32
    v_and_b32 v82, 0x3fc, v82
    v_bfi_b32 v68, 63, v32, v68
    v_lshl_add_u32 v68, v68, 20, v46
    v_alignbit_b32 v68, v68, v68, 30
    ds_add_rtn_u32 v96, v82, v6 offset:48384
    v_lshlrev_b32 v10, 16, v54
    v_and_b32 v11, 0xffff0000, v54
    v_mul_f32 v10, v7, v10
    v_mul_f32 v11, v7, v11
    v_cvt_pk_bf16_f32 v10, 0, v10
    v_cvt_pk_bf16_f32 v11, 0, v11
    v_mul_f32 v14, 0x3e22f900, v10
    v_mul_f32 v15, 0x3e22f900, v11
    v_fract_f32 v14, v14
    v_fract_f32 v15, v15
    v_fmamk_f32 v10, v10, 0x36036e4e, v14
    v_fmamk_f32 v11, v11, 0x36036e4e, v15
    v_cos_f32 v10, v10
    v_cos_f32 v11, v11
    s_nop 0
    v_cvt_pk_bf16_f32 v10, 0, v10
    v_cvt_pk_bf16_f32 v11, 0, v11
    v_cvt_pkrtz_f16_f32 v104, v10, v11
    v_pk_add_f16 v47, v47, v104
a_s13al:
    s_mov_b64 exec, -1
    s_lshl_b32 s31, s94, 4
    s_add_u32 s95, s31, s3
    s_cmp_lg_u32 s95, 20
    s_cbranch_scc1 a_novote
    s_mov_b32 s33, 131072
a_vspinv:
    v_lshrrev_b32 v18, 2, v5
    v_and_b32 v18, 0x7c, v18
    buffer_load_dword v18, v18, s[4:7], 0 offen sc1
    s_waitcnt vmcnt(0)
    v_cmp_gt_u32 vcc, 256, v18
    s_cmp_eq_u64 vcc, 0
    s_cbranch_scc1 a_vspunv
    s_sub_u32 s33, s33, 1
    s_cbranch_scc1 f_done
    s_sleep 32
    s_branch a_vspinv
a_vspunv:
    v_readfirstlane_b32 s32, v18
    s_lshr_b32 s31, s2, 3
    s_bfe_u32 s46, s32, 0x30001
    s_add_u32 s32, s46, s2
    s_and_b32 s32, s32, 7
    s_lshl_b32 s32, s32, 5
    s_add_u32 s35, s31, s32
    v_and_b32 v10, 1, v18
    v_cmp_eq_u32 vcc, 1, v10
    s_bcnt1_i32_b64 s31, vcc
    s_cmp_gt_u32 s31, 32
    s_cselect_b32 s31, 128, 0
    s_xor_b32 s35, s35, s31
    s_nop 1
    v_max_u32_dpp v18, v18, v18 row_shr:1 row_mask:0xf bank_mask:0xf
    s_nop 1
    v_max_u32_dpp v18, v18, v18 row_shr:2 row_mask:0xf bank_mask:0xf
    s_nop 1
    v_max_u32_dpp v18, v18, v18 row_shr:4 row_mask:0xf bank_mask:0xf
    s_nop 1
    v_max_u32_dpp v18, v18, v18 row_shr:8 row_mask:0xf bank_mask:0xf
    s_nop 1
    v_max_u32_dpp v18, v18, v18 row_bcast:15 row_mask:0xa bank_mask:0xf
    s_nop 1
    v_max_u32_dpp v18, v18, v18 row_bcast:31 row_mask:0xc bank_mask:0xf
    s_nop 0
    v_readlane_b32 s31, v18, 63
    s_nop 0
    s_lshr_b32 s31, s31, 23
    s_sub_u32 s34, 266, s31
    s_cmp_gt_u32 s34, 200
    s_cselect_b32 s34, 0, s34
    s_cmp_lt_u32 s34, 40
    s_cselect_b32 s34, 0, s34
    v_mov_b32 v10, s35
    v_mov_b32 v11, s34
    v_mov_b32 v12, s46
    v_mov_b32 v14, 0
    ds_write_b128 v14, v[10:13] offset:320
a_novote:
    s_cmp_lg_u32 s95, 36
    s_cbranch_scc1 a_noclear
    s_mov_b32 s33, 131072
a_vspinz:
    v_mov_b32 v18, 128
    buffer_load_dword v18, v18, s[4:7], 0 offen sc1
    s_waitcnt vmcnt(0)
    v_cmp_gt_u32 vcc, 256, v18
    s_cmp_eq_u64 vcc, 0
    s_cbranch_scc1 a_vspunz
    s_sub_u32 s33, s33, 1
    s_cbranch_scc1 f_done
    s_sleep 32
    s_branch a_vspinz
a_vspunz:
a_noclear:
    v_pk_add_f16 v10, v47, v47 op_sel:[0,1] op_sel_hi:[1,0]
    v_mov_b32 v11, 0
    v_mov_b32 v12, -1
    v_cmpx_u_f16 vcc, v10, v10
    ds_write_b32 v11, v12 offset:308
    s_mov_b64 exec, -1
    s_lshr_b32 s32, s40, 1
    buffer_load_dwordx4 v[20:23], v1, s[16:19], s40 offen nt
    buffer_load_dwordx4 v[34:37], v1, s[20:23], s40 offen nt
    buffer_load_dwordx2 v[48:49], v2, s[24:27], s32 offen nt
    s_add_u32 s40, s40, 12582912
    s_waitcnt vmcnt(9)
    s_cmp_lg_u32 s94, 0
    s_cbranch_scc1 a_noclrw
    s_waitcnt vmcnt(3)
a_noclrw:
    s_waitcnt lgkmcnt(0)
    s_barrier
    s_cmp_lg_u32 s95, 34
    s_cbranch_scc1 a_norowl
    s_sub_u32 s95, s94, 2
    s_and_b32 s31, s95, 3
    s_lshl_b32 s31, s31, 10
    v_add_u32 v10, s31, v5
    v_mov_b32 v14, 0
    ds_read_b128 v[10:13], v10 offset:2560
    ds_read_b32 v14, v14 offset:308
    s_lshl_b32 s31, s95, 18
    s_lshl_b32 s33, s2, 4
    s_add_u32 s31, s31, s33
    s_add_u32 s31, s31, 234881024
    s_or_b32 s32, s65, 0x80000000
    s_waitcnt lgkmcnt(0)
    v_or3_b32 v10, v10, s32, v14
    v_or3_b32 v11, v11, s32, v14
    v_or3_b32 v12, v12, s32, v14
    v_or3_b32 v13, v13, s32, v14
    v_lshlrev_b32 v14, 8, v5
    buffer_store_dwordx4 v[10:13], v14, s[8:11], s31 offen sc1
    s_nop 1
a_norowl:
    s_cmp_lg_u32 s66, 0
    s_cbranch_scc1 a_nosiga
    v_mov_b32 v10, 1
    v_mov_b32 v11, 128
    s_mov_b64 exec, 1
    buffer_atomic_add v10, v11, s[4:7], 0 offen sc1
    s_mov_b64 exec, -1
a_nosiga:
    s_sub_u32 s66, s66, 2
    s_cmp_lg_u32 s94, 1
    s_cbranch_scc1 a_noget
    v_mov_b32 v10, 0
    ds_read_b128 v[10:13], v10 offset:320
    s_waitcnt lgkmcnt(0)
    v_readfirstlane_b32 s35, v10
    v_readfirstlane_b32 s34, v11
    v_readfirstlane_b32 s46, v12
a_noget:
    s_cmp_lg_u32 s94, 1
    s_cbranch_scc1 a_nom
    s_load_dwordx2 s[68:69], s[0:1], 0
    s_load_dwordx2 s[72:73], s[0:1], 24
    s_mov_b32 s70, 6400000
    s_mov_b32 s71, 0x00020000
    s_mov_b32 s74, 1600000
    s_mov_b32 s75, 0x00020000
    v_and_b32 v12, 0x1f0, v5
    v_and_b32 v13, 0x200, v5
    v_lshl_or_b32 v12, v13, 8, v12
    s_waitcnt lgkmcnt(0)
    s_lshl_b32 s33, s3, 10
    s_add_u32 s33, s33, 23296
    s_mov_b32 m0, s33
    s_lshl_b32 s31, s3, 18
    s_lshl_b32 s32, s35, 9
    s_add_u32 s31, s31, s32
    buffer_load_dwordx4 v12, s[68:71], s31 offen lds
    s_cmp_gt_u32 s3, 8
    s_cbranch_scc1 a_nom2
    s_cmp_eq_u32 s3, 8
    s_cselect_b32 exec_hi, 0, -1
    s_add_u32 s33, s33, 16384
    s_mov_b32 m0, s33
    s_add_u32 s31, s31, 4194304
    buffer_load_dwordx4 v12, s[68:71], s31 offen lds
    s_mov_b64 exec, -1
a_nom2:
    s_cmp_lg_u32 s3, 11
    s_cbranch_scc1 a_nodpf
    s_lshl_b32 s31, s35, 7
    v_lshlrev_b32 v13, 11, v5
    buffer_load_dword v126, v13, s[72:75], s31 offen
a_nodpf:
    s_lshr_b32 s31, s35, 2
    s_lshl_b32 s31, s31, 12
    s_and_b32 s32, s35, 3
    s_lshl_b32 s32, s32, 2
    s_add_u32 s31, s31, s32
    s_lshr_b32 s32, s3, 2
    s_lshl_b32 s32, s32, 10
    s_add_u32 s31, s31, s32
    s_add_u32 s38, s31, 234881024
    s_mov_b32 s39, 0
    s_mov_b32 s52, 0
    s_lshl_b32 s48, s3, 9
    s_mov_b32 s49, 0x00070007
    s_mov_b32 s50, 0x00000002
    s_mov_b32 s56, 0x00030005
    s_mov_b32 s51, 8224
a_nom:
    ds_read_b128 v[10:13], v5 offset:48384
    s_cmp_eq_u32 s94, 0
    s_cbranch_scc1 a_nocommit
    s_max_u32 s31, s64, s47
    s_cmp_gt_u32 s31, 40800
    s_cselect_b32 s65, -1, s65
    s_cmp_eq_u32 s45, 0
    s_cselect_b32 s61, s64, s47
    s_cselect_b32 s63, s47, s64
    s_mov_b32 s60, s30
    s_xor_b32 s62, s60, 0x2000
    s_min_u32 s61, s61, 40800
    s_mul_i32 s31, s61, 32897
    s_lshr_b32 s31, s31, 28
    s_mul_i32 s31, s31, 8224
    s_add_u32 s61, s61, s31
    s_add_u32 s61, s61, 127
    s_and_b32 s61, s61, 0xffffff80
    s_add_u32 s61, s61, s60
    s_min_u32 s63, s63, 40800
    s_mul_i32 s31, s63, 32897
    s_lshr_b32 s31, s31, 28
    s_mul_i32 s31, s31, 8224
    s_add_u32 s63, s63, s31
    s_add_u32 s63, s63, 127
    s_and_b32 s63, s63, 0xffffff80
    s_add_u32 s63, s63, s62
    s_add_u32 s30, s30, 25165824
a_nocommit:
    s_add_u32 s31, s60, 0
    s_mov_b32 s14, s61
    buffer_store_dwordx4 v[106:109], v83, s[12:15], s31 offen sc1
    s_add_u32 s31, s62, 16384
    s_mov_b32 s14, s63
    buffer_store_dwordx4 v[110:113], v83, s[12:15], s31 offen sc1
    s_waitcnt lgkmcnt(0)
    v_sub_u32 v14, v10, v4
    v_sub_u32 v15, v11, v9
    v_sub_u32 v16, v12, v55
    v_sub_u32 v17, v13, v69
    v_and_b32 v19, 2, v14
    v_mad_u32_u24 v14, v19, 3, v14
    v_and_b32 v19, 2, v15
    v_mad_u32_u24 v15, v19, 3, v15
    v_and_b32 v19, 2, v16
    v_mad_u32_u24 v16, v19, 3, v16
    v_and_b32 v19, 2, v17
    v_mad_u32_u24 v17, v19, 3, v17
    v_add_u32 v19, v14, v15
    v_add3_u32 v19, v19, v16, v17
    v_mov_b32 v18, v19
    s_nop 1
    v_add_u32_dpp v18, v18, v18 row_shr:1 row_mask:0xf bank_mask:0xf
    s_nop 1
    v_add_u32_dpp v18, v18, v18 row_shr:2 row_mask:0xf bank_mask:0xf
    s_nop 1
    v_add_u32_dpp v18, v18, v18 row_shr:4 row_mask:0xf bank_mask:0xf
    s_nop 1
    v_add_u32_dpp v18, v18, v18 row_shr:8 row_mask:0xf bank_mask:0xf
    s_nop 1
    v_add_u32_dpp v18, v18, v18 row_bcast:15 row_mask:0xa bank_mask:0xf
    v_sub_u32 v19, v18, v19
    v_readlane_b32 s64, v18, 31
    v_readlane_b32 s47, v18, 63
    v_add3_u32 v18, v19, 2, v97
    v_sub_u32 v4, v18, v4
    v_swap_b32 v4, v10
    v_add_u32 v18, v18, v14
    v_sub_u32 v9, v18, v9
    v_swap_b32 v9, v11
    v_add_u32 v18, v18, v15
    v_sub_u32 v55, v18, v55
    v_swap_b32 v55, v12
    v_add_u32 v18, v18, v16
    v_sub_u32 v69, v18, v69
    v_swap_b32 v69, v13
    ds_write_b128 v5, v[10:13] offset:49408
    ds_read_b32 v70, v70 offset:49408
    ds_read_b32 v71, v71 offset:49408
    ds_read_b32 v72, v72 offset:49408
    ds_read_b32 v73, v73 offset:49408
    ds_read_b32 v74, v74 offset:49408
    ds_read_b32 v75, v75 offset:49408
    ds_read_b32 v76, v76 offset:49408
    ds_read_b32 v77, v77 offset:49408
    ds_read_b32 v78, v78 offset:49408
    ds_read_b32 v79, v79 offset:49408
    ds_read_b32 v80, v80 offset:49408
    ds_read_b32 v81, v81 offset:49408
    s_mov_b64 exec, s[36:37]
    s_cbranch_execz a_s13rl
    ds_read_b32 v82, v82 offset:49408
a_s13rl:
    s_mov_b64 exec, -1
    s_cmp_lt_u32 s3, 14
    s_cbranch_scc1 a_dutyBl
    s_cmp_lg_u32 s3, 15
    s_cbranch_scc1 a_dutyAl
    v_lshrrev_b32 v19, 2, v19
    v_mul_u32_u24 v19, 21846, v19
    v_lshrrev_b32 v19, 16, v19
    v_lshrrev_b32 v33, 2, v14
    v_mul_u32_u24 v33, 21846, v33
    v_lshrrev_b32 v33, 16, v33
    v_lshl_or_b32 v14, v33, 13, v19
    v_add_u32 v19, v19, v33
    v_lshrrev_b32 v33, 2, v15
    v_mul_u32_u24 v33, 21846, v33
    v_lshrrev_b32 v33, 16, v33
    v_lshl_or_b32 v15, v33, 13, v19
    v_add_u32 v19, v19, v33
    v_lshrrev_b32 v33, 2, v16
    v_mul_u32_u24 v33, 21846, v33
    v_lshrrev_b32 v33, 16, v33
    v_lshl_or_b32 v16, v33, 13, v19
    v_add_u32 v19, v19, v33
    v_lshrrev_b32 v33, 2, v17
    v_mul_u32_u24 v33, 21846, v33
    v_lshrrev_b32 v33, 16, v33
    v_lshl_or_b32 v17, v33, 13, v19
    v_add_u32 v19, v19, v33
    s_lshl_b32 s31, s94, 10
    v_add_u32 v19, s31, v5
    ds_write_b128 v19, v[14:17] offset:2560
a_dutyAl:
    s_cmp_lg_u32 s3, 14
    s_cbranch_scc1 a_dutyBl
    s_lshl_b32 s31, s2, 2
    s_add_u32 s31, s31, s94
    s_mul_i32 s31, s31, 260
    v_lshl_add_u32 v33, v5, 6, s31
    v_add_u32 v19, 0, v33
    v_and_b32 v19, 0xffff, v19
    v_or_b32 v19, 3211264, v19
    v_add_u32 v18, v10, v4
    v_and_b32 v14, 2, v18
    v_cmpx_eq_u32 vcc, 0, v14
    ds_write_b32 v18, v19 offset:50432
    ds_write_b16 v18, v14 offset:50430
    s_mov_b64 exec, -1
    v_add_u32 v19, 256, v33
    v_and_b32 v19, 0xffff, v19
    v_or_b32 v19, 3211264, v19
    v_add_u32 v18, v11, v9
    v_and_b32 v15, 2, v18
    v_cmpx_eq_u32 vcc, 0, v15
    ds_write_b32 v18, v19 offset:50432
    ds_write_b16 v18, v15 offset:50430
    s_mov_b64 exec, -1
    v_add_u32 v19, 512, v33
    v_and_b32 v19, 0xffff, v19
    v_or_b32 v19, 3211264, v19
    v_add_u32 v18, v12, v55
    v_and_b32 v16, 2, v18
    v_cmpx_eq_u32 vcc, 0, v16
    ds_write_b32 v18, v19 offset:50432
    ds_write_b16 v18, v16 offset:50430
    s_mov_b64 exec, -1
    v_add_u32 v19, 768, v33
    v_and_b32 v19, 0xffff, v19
    v_or_b32 v19, 3211264, v19
    v_add_u32 v18, v13, v69
    v_and_b32 v17, 2, v18
    v_cmpx_eq_u32 vcc, 0, v17
    ds_write_b32 v18, v19 offset:50432
    ds_write_b16 v18, v17 offset:50430
    s_mov_b64 exec, -1
a_dutyBl:
    s_lshr_b32 s32, s41, 1
    buffer_load_dwordx4 v[24:27], v1, s[16:19], s41 offen nt
    buffer_load_dwordx4 v[38:41], v1, s[20:23], s41 offen nt
    buffer_load_dwordx2 v[50:51], v2, s[24:27], s32 offen nt
    s_add_u32 s41, s41, 12582912
    s_waitcnt lgkmcnt(0)
    v_add_u32 v84, v84, v70
    v_and_b32 v70, -4, v84
    v_sub_u32 v19, v84, v70
    v_lshl_add_u32 v84, v19, 1, v84
    ds_write_b32 v70, v56 offset:50432
    ds_write_b16 v84, v98 offset:50430
    v_add_u32 v85, v85, v71
    v_and_b32 v71, -4, v85
    v_sub_u32 v19, v85, v71
    v_lshl_add_u32 v85, v19, 1, v85
    ds_write_b32 v71, v57 offset:50432
    ds_write_b16_d16_hi v85, v98 offset:50430
    v_add_u32 v86, v86, v72
    v_and_b32 v72, -4, v86
    v_sub_u32 v19, v86, v72
    v_lshl_add_u32 v86, v19, 1, v86
    ds_write_b32 v72, v58 offset:50432
    ds_write_b16 v86, v99 offset:50430
    v_add_u32 v87, v87, v73
    v_and_b32 v73, -4, v87
    v_sub_u32 v19, v87, v73
    v_lshl_add_u32 v87, v19, 1, v87
    ds_write_b32 v73, v59 offset:50432
    ds_write_b16_d16_hi v87, v99 offset:50430
    v_add_u32 v88, v88, v74
    v_and_b32 v74, -4, v88
    v_sub_u32 v19, v88, v74
    v_lshl_add_u32 v88, v19, 1, v88
    ds_write_b32 v74, v60 offset:50432
    ds_write_b16 v88, v100 offset:50430
    v_add_u32 v89, v89, v75
    v_and_b32 v75, -4, v89
    v_sub_u32 v19, v89, v75
    v_lshl_add_u32 v89, v19, 1, v89
    ds_write_b32 v75, v61 offset:50432
    ds_write_b16_d16_hi v89, v100 offset:50430
    s_add_u32 s31, s60, 32768
    s_mov_b32 s14, s61
    buffer_store_dwordx4 v[114:117], v83, s[12:15], s31 offen sc1
    s_add_u32 s31, s62, 49152
    s_mov_b32 s14, s63
    buffer_store_dwordx4 v[118:121], v83, s[12:15], s31 offen sc1
    v_add_u32 v90, v90, v76
    v_and_b32 v76, -4, v90
    v_sub_u32 v19, v90, v76
    v_lshl_add_u32 v90, v19, 1, v90
    ds_write_b32 v76, v62 offset:50432
    ds_write_b16 v90, v101 offset:50430
    v_add_u32 v91, v91, v77
    v_and_b32 v77, -4, v91
    v_sub_u32 v19, v91, v77
    v_lshl_add_u32 v91, v19, 1, v91
    ds_write_b32 v77, v63 offset:50432
    ds_write_b16_d16_hi v91, v101 offset:50430
    v_add_u32 v92, v92, v78
    v_and_b32 v78, -4, v92
    v_sub_u32 v19, v92, v78
    v_lshl_add_u32 v92, v19, 1, v92
    ds_write_b32 v78, v64 offset:50432
    ds_write_b16 v92, v102 offset:50430
    v_add_u32 v93, v93, v79
    v_and_b32 v79, -4, v93
    v_sub_u32 v19, v93, v79
    v_lshl_add_u32 v93, v19, 1, v93
    ds_write_b32 v79, v65 offset:50432
    ds_write_b16_d16_hi v93, v102 offset:50430
    v_add_u32 v94, v94, v80
    v_and_b32 v80, -4, v94
    v_sub_u32 v19, v94, v80
    v_lshl_add_u32 v94, v19, 1, v94
    ds_write_b32 v80, v66 offset:50432
    ds_write_b16 v94, v103 offset:50430
    v_add_u32 v95, v95, v81
    v_and_b32 v81, -4, v95
    v_sub_u32 v19, v95, v81
    v_lshl_add_u32 v95, v19, 1, v95
    ds_write_b32 v81, v67 offset:50432
    ds_write_b16_d16_hi v95, v103 offset:50430
    s_mov_b64 exec, s[36:37]
    s_cbranch_execz a_s13bl
    v_add_u32 v96, v96, v82
    v_and_b32 v82, -4, v96
    v_sub_u32 v19, v96, v82
    v_lshl_add_u32 v96, v19, 1, v96
    ds_write_b32 v82, v68 offset:50432
    ds_write_b16 v96, v104 offset:50430
a_s13bl:
    s_mov_b64 exec, -1
    s_cmp_lg_u32 s94, 2
    s_cbranch_scc1 a_noearly
    v_lshlrev_b32 v66, 4, v0
    v_lshrrev_b32 v67, 4, v5
    v_and_b32 v64, 3, v0
    v_lshlrev_b32 v64, 6, v64
    ds_read_b64 v[64:65], v64 offset:40
    ds_read_b128 v[56:59], v66 offset:23296
    ds_read_b128 v[60:63], v66 offset:39680
    s_waitcnt lgkmcnt(0)
    s_lshl_b32 s32, s34, 23
    s_mov_b32 s33, s32
    v_mov_b32 v88, 0
    v_mfma_f32_4x4x4_16b_bf16 v[70:73], v[64:65], v[56:57], 0
    v_mfma_f32_4x4x4_16b_bf16 v[74:77], v[64:65], v[58:59], 0
    s_nop 3
    v_cvt_pk_bf16_f32 v70, 0, v70
    v_cvt_pk_bf16_f32 v71, 0, v71
    v_pk_mul_f32 v[70:71], v[70:71], s[32:33]
    v_cvt_pkrtz_f16_f32 v84, v70, v71
    v_and_b32 v70, 0x7fff7fff, v84
    v_pk_max_u16 v88, v88, v70
    v_cvt_pk_bf16_f32 v72, 0, v72
    v_cvt_pk_bf16_f32 v73, 0, v73
    v_pk_mul_f32 v[72:73], v[72:73], s[32:33]
    v_cvt_pkrtz_f16_f32 v85, v72, v73
    v_and_b32 v72, 0x7fff7fff, v85
    v_pk_max_u16 v88, v88, v72
    v_cvt_pk_bf16_f32 v74, 0, v74
    v_cvt_pk_bf16_f32 v75, 0, v75
    v_pk_mul_f32 v[74:75], v[74:75], s[32:33]
    v_cvt_pkrtz_f16_f32 v86, v74, v75
    v_and_b32 v74, 0x7fff7fff, v86
    v_pk_max_u16 v88, v88, v74
    v_cvt_pk_bf16_f32 v76, 0, v76
    v_cvt_pk_bf16_f32 v77, 0, v77
    v_pk_mul_f32 v[76:77], v[76:77], s[32:33]
    v_cvt_pkrtz_f16_f32 v87, v76, v77
    v_and_b32 v76, 0x7fff7fff, v87
    v_pk_max_u16 v88, v88, v76
    ds_write_b128 v66, v[84:87] offset:23296
    s_cmp_gt_u32 s3, 8
    s_cbranch_scc1 a_tab1
    v_mfma_f32_4x4x4_16b_bf16 v[70:73], v[64:65], v[60:61], 0
    v_mfma_f32_4x4x4_16b_bf16 v[74:77], v[64:65], v[62:63], 0
    s_nop 3
    s_cmp_eq_u32 s3, 8
    s_cselect_b32 exec_hi, 0, -1
    v_cvt_pk_bf16_f32 v70, 0, v70
    v_cvt_pk_bf16_f32 v71, 0, v71
    v_pk_mul_f32 v[70:71], v[70:71], s[32:33]
    v_cvt_pkrtz_f16_f32 v84, v70, v71
    v_and_b32 v70, 0x7fff7fff, v84
    v_pk_max_u16 v88, v88, v70
    v_cvt_pk_bf16_f32 v72, 0, v72
    v_cvt_pk_bf16_f32 v73, 0, v73
    v_pk_mul_f32 v[72:73], v[72:73], s[32:33]
    v_cvt_pkrtz_f16_f32 v85, v72, v73
    v_and_b32 v72, 0x7fff7fff, v85
    v_pk_max_u16 v88, v88, v72
    v_cvt_pk_bf16_f32 v74, 0, v74
    v_cvt_pk_bf16_f32 v75, 0, v75
    v_pk_mul_f32 v[74:75], v[74:75], s[32:33]
    v_cvt_pkrtz_f16_f32 v86, v74, v75
    v_and_b32 v74, 0x7fff7fff, v86
    v_pk_max_u16 v88, v88, v74
    v_cvt_pk_bf16_f32 v76, 0, v76
    v_cvt_pk_bf16_f32 v77, 0, v77
    v_pk_mul_f32 v[76:77], v[76:77], s[32:33]
    v_cvt_pkrtz_f16_f32 v87, v76, v77
    v_and_b32 v76, 0x7fff7fff, v87
    v_pk_max_u16 v88, v88, v76
    ds_write_b128 v66, v[84:87] offset:39680
    s_mov_b64 exec, -1
a_tab1:
    v_lshrrev_b32 v70, 16, v88
    v_and_b32 v88, 0xffff, v88
    v_max_u32 v88, v88, v70
    v_cmp_le_u32 vcc, 29696, v88
    s_cmp_lg_u64 vcc, 0
    s_cselect_b32 s33, 1, 0
    s_cmp_eq_u32 s34, 0
    s_cselect_b32 s33, 1, s33
    s_cmp_eq_u32 s33, 0
    s_cbranch_scc1 a_tabok
    v_mov_b32 v70, 0
    v_mov_b32 v71, -1
    ds_write_b32 v70, v71 offset:308
a_tabok:
a_noearly:
    s_add_u32 s31, s60, 65536
    s_mov_b32 s14, s61
    buffer_store_dwordx4 v[122:125], v83, s[12:15], s31 offen sc1
    s_add_u32 s94, s94, 1
    s_waitcnt lgkmcnt(0)
    s_barrier
    s_cmp_lt_u32 s94, 3
    s_cbranch_scc1 a_loop
    ds_read_b128 v[106:109], v8 offset:0
    ds_read_b128 v[110:113], v105 offset:8160
    ds_read_b128 v[114:117], v8 offset:16320
    ds_read_b128 v[118:121], v105 offset:24480
    ds_read_b128 v[122:125], v8 offset:32640
    s_lshr_b32 s32, s42, 1
    buffer_load_dwordx4 v[28:31], v1, s[16:19], s42 offen nt
    buffer_load_dwordx4 v[42:45], v1, s[20:23], s42 offen nt
    buffer_load_dwordx2 v[52:53], v2, s[24:27], s32 offen nt
    s_add_u32 s42, s42, 12582912
    s_lshr_b32 s32, s43, 1
    v_lshrrev_b32 v54, 1, v3
    buffer_load_dword v32, v3, s[16:19], s43 offen nt
    buffer_load_dword v46, v3, s[20:23], s43 offen nt
    buffer_load_ushort v54, v54, s[24:27], s32 offen nt
    s_add_u32 s43, s43, 217088
    v_lshrrev_b32 v3, 4, v5
    v_lshlrev_b32 v2, 4, v0
    s_waitcnt vmcnt(6)
    v_mov_b32 v11, 1
    v_mov_b32 v10, 0
    s_mov_b64 exec, 1
    ds_add_rtn_u32 v10, v10, v11 offset:296
    s_mov_b64 exec, -1
    s_waitcnt lgkmcnt(0)
    v_readfirstlane_b32 s95, v10
    s_nop 0
    s_cmp_lg_u32 s95, 15
    s_cbranch_scc1 f_norow1
    s_mov_b32 s95, 1
    s_and_b32 s31, s95, 3
    s_lshl_b32 s31, s31, 10
    v_add_u32 v10, s31, v5
    v_mov_b32 v14, 0
    ds_read_b128 v[10:13], v10 offset:2560
    ds_read_b32 v14, v14 offset:308
    s_lshl_b32 s31, s95, 18
    s_lshl_b32 s33, s2, 4
    s_add_u32 s31, s31, s33
    s_add_u32 s31, s31, 234881024
    s_or_b32 s32, s65, 0x80000000
    s_waitcnt lgkmcnt(0)
    v_or3_b32 v10, v10, s32, v14
    v_or3_b32 v11, v11, s32, v14
    v_or3_b32 v12, v12, s32, v14
    v_or3_b32 v13, v13, s32, v14
    v_lshlrev_b32 v14, 8, v5
    buffer_store_dwordx4 v[10:13], v14, s[8:11], s31 offen sc1
    s_nop 1
f_norow1:
    s_waitcnt vmcnt(14)
    v_lshrrev_b32 v70, 4, v20
    v_lshrrev_b32 v56, 8, v20
    v_and_b32 v70, 0x3fc, v70
    v_bfi_b32 v56, 63, v20, v56
    v_lshl_add_u32 v56, v56, 20, v34
    v_alignbit_b32 v56, v56, v56, 30
    v_lshrrev_b32 v71, 4, v21
    v_lshrrev_b32 v57, 8, v21
    v_and_b32 v71, 0x3fc, v71
    v_bfi_b32 v57, 63, v21, v57
    v_lshl_add_u32 v57, v57, 20, v35
    v_alignbit_b32 v57, v57, v57, 30
    v_lshrrev_b32 v72, 4, v22
    v_lshrrev_b32 v58, 8, v22
    v_and_b32 v72, 0x3fc, v72
    v_bfi_b32 v58, 63, v22, v58
    v_lshl_add_u32 v58, v58, 20, v36
    v_alignbit_b32 v58, v58, v58, 30
    v_lshrrev_b32 v73, 4, v23
    v_lshrrev_b32 v59, 8, v23
    v_and_b32 v73, 0x3fc, v73
    v_bfi_b32 v59, 63, v23, v59
    v_lshl_add_u32 v59, v59, 20, v37
    v_alignbit_b32 v59, v59, v59, 30
    s_waitcnt lgkmcnt(0)
    ds_add_rtn_u32 v84, v70, v6 offset:48384
    ds_add_rtn_u32 v85, v71, v6 offset:48384
    ds_add_rtn_u32 v86, v72, v6 offset:48384
    ds_add_rtn_u32 v87, v73, v6 offset:48384
    v_lshlrev_b32 v10, 16, v48
    v_and_b32 v11, 0xffff0000, v48
    v_lshlrev_b32 v12, 16, v49
    v_and_b32 v13, 0xffff0000, v49
    v_mul_f32 v10, v7, v10
    v_mul_f32 v11, v7, v11
    v_mul_f32 v12, v7, v12
    v_mul_f32 v13, v7, v13
    v_cvt_pk_bf16_f32 v10, 0, v10
    v_cvt_pk_bf16_f32 v11, 0, v11
    v_cvt_pk_bf16_f32 v12, 0, v12
    v_cvt_pk_bf16_f32 v13, 0, v13
    v_mul_f32 v14, 0x3e22f900, v10
    v_mul_f32 v15, 0x3e22f900, v11
    v_mul_f32 v16, 0x3e22f900, v12
    v_mul_f32 v17, 0x3e22f900, v13
    v_fract_f32 v14, v14
    v_fract_f32 v15, v15
    v_fract_f32 v16, v16
    v_fract_f32 v17, v17
    v_fmamk_f32 v10, v10, 0x36036e4e, v14
    v_fmamk_f32 v11, v11, 0x36036e4e, v15
    v_fmamk_f32 v12, v12, 0x36036e4e, v16
    v_fmamk_f32 v13, v13, 0x36036e4e, v17
    v_cos_f32 v10, v10
    v_cos_f32 v11, v11
    v_cos_f32 v12, v12
    v_cos_f32 v13, v13
    s_nop 0
    v_cvt_pk_bf16_f32 v10, 0, v10
    v_cvt_pk_bf16_f32 v11, 0, v11
    v_cvt_pk_bf16_f32 v12, 0, v12
    v_cvt_pk_bf16_f32 v13, 0, v13
    v_cvt_pkrtz_f16_f32 v98, v10, v11
    v_cvt_pkrtz_f16_f32 v99, v12, v13
    v_pk_add_f16 v47, v47, v98
    v_pk_add_f16 v47, v47, v99
    s_waitcnt vmcnt(9)
    v_lshrrev_b32 v74, 4, v24
    v_lshrrev_b32 v60, 8, v24
    v_and_b32 v74, 0x3fc, v74
    v_bfi_b32 v60, 63, v24, v60
    v_lshl_add_u32 v60, v60, 20, v38
    v_alignbit_b32 v60, v60, v60, 30
    v_lshrrev_b32 v75, 4, v25
    v_lshrrev_b32 v61, 8, v25
    v_and_b32 v75, 0x3fc, v75
    v_bfi_b32 v61, 63, v25, v61
    v_lshl_add_u32 v61, v61, 20, v39
    v_alignbit_b32 v61, v61, v61, 30
    v_lshrrev_b32 v76, 4, v26
    v_lshrrev_b32 v62, 8, v26
    v_and_b32 v76, 0x3fc, v76
    v_bfi_b32 v62, 63, v26, v62
    v_lshl_add_u32 v62, v62, 20, v40
    v_alignbit_b32 v62, v62, v62, 30
    v_lshrrev_b32 v77, 4, v27
    v_lshrrev_b32 v63, 8, v27
    v_and_b32 v77, 0x3fc, v77
    v_bfi_b32 v63, 63, v27, v63
    v_lshl_add_u32 v63, v63, 20, v41
    v_alignbit_b32 v63, v63, v63, 30
    ds_add_rtn_u32 v88, v74, v6 offset:48384
    ds_add_rtn_u32 v89, v75, v6 offset:48384
    ds_add_rtn_u32 v90, v76, v6 offset:48384
    ds_add_rtn_u32 v91, v77, v6 offset:48384
    v_lshlrev_b32 v10, 16, v50
    v_and_b32 v11, 0xffff0000, v50
    v_lshlrev_b32 v12, 16, v51
    v_and_b32 v13, 0xffff0000, v51
    v_mul_f32 v10, v7, v10
    v_mul_f32 v11, v7, v11
    v_mul_f32 v12, v7, v12
    v_mul_f32 v13, v7, v13
    v_cvt_pk_bf16_f32 v10, 0, v10
    v_cvt_pk_bf16_f32 v11, 0, v11
    v_cvt_pk_bf16_f32 v12, 0, v12
    v_cvt_pk_bf16_f32 v13, 0, v13
    v_mul_f32 v14, 0x3e22f900, v10
    v_mul_f32 v15, 0x3e22f900, v11
    v_mul_f32 v16, 0x3e22f900, v12
    v_mul_f32 v17, 0x3e22f900, v13
    v_fract_f32 v14, v14
    v_fract_f32 v15, v15
    v_fract_f32 v16, v16
    v_fract_f32 v17, v17
    v_fmamk_f32 v10, v10, 0x36036e4e, v14
    v_fmamk_f32 v11, v11, 0x36036e4e, v15
    v_fmamk_f32 v12, v12, 0x36036e4e, v16
    v_fmamk_f32 v13, v13, 0x36036e4e, v17
    v_cos_f32 v10, v10
    v_cos_f32 v11, v11
    v_cos_f32 v12, v12
    v_cos_f32 v13, v13
    s_nop 0
    v_cvt_pk_bf16_f32 v10, 0, v10
    v_cvt_pk_bf16_f32 v11, 0, v11
    v_cvt_pk_bf16_f32 v12, 0, v12
    v_cvt_pk_bf16_f32 v13, 0, v13
    v_cvt_pkrtz_f16_f32 v100, v10, v11
    v_cvt_pkrtz_f16_f32 v101, v12, v13
    v_pk_add_f16 v47, v47, v100
    v_pk_add_f16 v47, v47, v101
    s_waitcnt vmcnt(3)
    v_lshrrev_b32 v78, 4, v28
    v_lshrrev_b32 v64, 8, v28
    v_and_b32 v78, 0x3fc, v78
    v_bfi_b32 v64, 63, v28, v64
    v_lshl_add_u32 v64, v64, 20, v42
    v_alignbit_b32 v64, v64, v64, 30
    v_lshrrev_b32 v79, 4, v29
    v_lshrrev_b32 v65, 8, v29
    v_and_b32 v79, 0x3fc, v79
    v_bfi_b32 v65, 63, v29, v65
    v_lshl_add_u32 v65, v65, 20, v43
    v_alignbit_b32 v65, v65, v65, 30
    v_lshrrev_b32 v80, 4, v30
    v_lshrrev_b32 v66, 8, v30
    v_and_b32 v80, 0x3fc, v80
    v_bfi_b32 v66, 63, v30, v66
    v_lshl_add_u32 v66, v66, 20, v44
    v_alignbit_b32 v66, v66, v66, 30
    v_lshrrev_b32 v81, 4, v31
    v_lshrrev_b32 v67, 8, v31
    v_and_b32 v81, 0x3fc, v81
    v_bfi_b32 v67, 63, v31, v67
    v_lshl_add_u32 v67, v67, 20, v45
    v_alignbit_b32 v67, v67, v67, 30
    ds_add_rtn_u32 v92, v78, v6 offset:48384
    ds_add_rtn_u32 v93, v79, v6 offset:48384
    ds_add_rtn_u32 v94, v80, v6 offset:48384
    ds_add_rtn_u32 v95, v81, v6 offset:48384
    v_lshlrev_b32 v10, 16, v52
    v_and_b32 v11, 0xffff0000, v52
    v_lshlrev_b32 v12, 16, v53
    v_and_b32 v13, 0xffff0000, v53
    v_mul_f32 v10, v7, v10
    v_mul_f32 v11, v7, v11
    v_mul_f32 v12, v7, v12
    v_mul_f32 v13, v7, v13
    v_cvt_pk_bf16_f32 v10, 0, v10
    v_cvt_pk_bf16_f32 v11, 0, v11
    v_cvt_pk_bf16_f32 v12, 0, v12
    v_cvt_pk_bf16_f32 v13, 0, v13
    v_mul_f32 v14, 0x3e22f900, v10
    v_mul_f32 v15, 0x3e22f900, v11
    v_mul_f32 v16, 0x3e22f900, v12
    v_mul_f32 v17, 0x3e22f900, v13
    v_fract_f32 v14, v14
    v_fract_f32 v15, v15
    v_fract_f32 v16, v16
    v_fract_f32 v17, v17
    v_fmamk_f32 v10, v10, 0x36036e4e, v14
    v_fmamk_f32 v11, v11, 0x36036e4e, v15
    v_fmamk_f32 v12, v12, 0x36036e4e, v16
    v_fmamk_f32 v13, v13, 0x36036e4e, v17
    v_cos_f32 v10, v10
    v_cos_f32 v11, v11
    v_cos_f32 v12, v12
    v_cos_f32 v13, v13
    s_nop 0
    v_cvt_pk_bf16_f32 v10, 0, v10
    v_cvt_pk_bf16_f32 v11, 0, v11
    v_cvt_pk_bf16_f32 v12, 0, v12
    v_cvt_pk_bf16_f32 v13, 0, v13
    v_cvt_pkrtz_f16_f32 v102, v10, v11
    v_cvt_pkrtz_f16_f32 v103, v12, v13
    v_pk_add_f16 v47, v47, v102
    v_pk_add_f16 v47, v47, v103
    s_waitcnt vmcnt(0)
    s_mov_b64 exec, s[36:37]
    s_cbranch_execz a_s13az
    v_lshrrev_b32 v82, 4, v32
    v_lshrrev_b32 v68, 8, v32
    v_and_b32 v82, 0x3fc, v82
    v_bfi_b32 v68, 63, v32, v68
    v_lshl_add_u32 v68, v68, 20, v46
    v_alignbit_b32 v68, v68, v68, 30
    ds_add_rtn_u32 v96, v82, v6 offset:48384
    v_lshlrev_b32 v10, 16, v54
    v_and_b32 v11, 0xffff0000, v54
    v_mul_f32 v10, v7, v10
    v_mul_f32 v11, v7, v11
    v_cvt_pk_bf16_f32 v10, 0, v10
    v_cvt_pk_bf16_f32 v11, 0, v11
    v_mul_f32 v14, 0x3e22f900, v10
    v_mul_f32 v15, 0x3e22f900, v11
    v_fract_f32 v14, v14
    v_fract_f32 v15, v15
    v_fmamk_f32 v10, v10, 0x36036e4e, v14
    v_fmamk_f32 v11, v11, 0x36036e4e, v15
    v_cos_f32 v10, v10
    v_cos_f32 v11, v11
    s_nop 0
    v_cvt_pk_bf16_f32 v10, 0, v10
    v_cvt_pk_bf16_f32 v11, 0, v11
    v_cvt_pkrtz_f16_f32 v104, v10, v11
    v_pk_add_f16 v47, v47, v104
a_s13az:
    s_mov_b64 exec, -1
    s_lshl_b32 s31, s94, 4
    s_add_u32 s95, s31, s3
    v_pk_add_f16 v10, v47, v47 op_sel:[0,1] op_sel_hi:[1,0]
    v_mov_b32 v11, 0
    v_mov_b32 v12, -1
    v_cmpx_u_f16 vcc, v10, v10
    ds_write_b32 v11, v12 offset:308
    s_mov_b64 exec, -1
    s_waitcnt vmcnt(6)
    s_waitcnt lgkmcnt(0)
    s_barrier
    ds_read_b128 v[10:13], v5 offset:48384
    s_add_u32 s31, s38, 262144
    v_lshlrev_b32 v49, 0, v5
    buffer_load_dword v49, v49, s[8:11], s31 offen sc1
    s_lshl_b32 s31, s39, 18
    s_add_u32 s31, s31, s38
    buffer_load_dword v48, v5, s[8:11], s31 offen sc1
    s_max_u32 s31, s64, s47
    s_cmp_gt_u32 s31, 40800
    s_cselect_b32 s65, -1, s65
    s_cmp_eq_u32 s45, 0
    s_cselect_b32 s61, s64, s47
    s_cselect_b32 s63, s47, s64
    s_mov_b32 s60, s30
    s_xor_b32 s62, s60, 0x2000
    s_min_u32 s61, s61, 40800
    s_mul_i32 s31, s61, 32897
    s_lshr_b32 s31, s31, 28
    s_mul_i32 s31, s31, 8224
    s_add_u32 s61, s61, s31
    s_add_u32 s61, s61, 127
    s_and_b32 s61, s61, 0xffffff80
    s_add_u32 s61, s61, s60
    s_min_u32 s63, s63, 40800
    s_mul_i32 s31, s63, 32897
    s_lshr_b32 s31, s31, 28
    s_mul_i32 s31, s31, 8224
    s_add_u32 s63, s63, s31
    s_add_u32 s63, s63, 127
    s_and_b32 s63, s63, 0xffffff80
    s_add_u32 s63, s63, s62
    s_add_u32 s30, s30, 25165824
    s_waitcnt lgkmcnt(0)
    v_sub_u32 v14, v10, v4
    v_sub_u32 v15, v11, v9
    v_sub_u32 v16, v12, v55
    v_sub_u32 v17, v13, v69
    v_and_b32 v19, 2, v14
    v_mad_u32_u24 v14, v19, 3, v14
    v_and_b32 v19, 2, v15
    v_mad_u32_u24 v15, v19, 3, v15
    v_and_b32 v19, 2, v16
    v_mad_u32_u24 v16, v19, 3, v16
    v_and_b32 v19, 2, v17
    v_mad_u32_u24 v17, v19, 3, v17
    v_add_u32 v19, v14, v15
    v_add3_u32 v19, v19, v16, v17
    v_mov_b32 v18, v19
    s_nop 1
    v_add_u32_dpp v18, v18, v18 row_shr:1 row_mask:0xf bank_mask:0xf
    s_nop 1
    v_add_u32_dpp v18, v18, v18 row_shr:2 row_mask:0xf bank_mask:0xf
    s_nop 1
    v_add_u32_dpp v18, v18, v18 row_shr:4 row_mask:0xf bank_mask:0xf
    s_nop 1
    v_add_u32_dpp v18, v18, v18 row_shr:8 row_mask:0xf bank_mask:0xf
    s_nop 1
    v_add_u32_dpp v18, v18, v18 row_bcast:15 row_mask:0xa bank_mask:0xf
    v_sub_u32 v19, v18, v19
    v_readlane_b32 s64, v18, 31
    v_readlane_b32 s47, v18, 63
    v_add3_u32 v18, v19, 2, v97
    v_sub_u32 v4, v18, v4
    v_swap_b32 v4, v10
    v_add_u32 v18, v18, v14
    v_sub_u32 v9, v18, v9
    v_swap_b32 v9, v11
    v_add_u32 v18, v18, v15
    v_sub_u32 v55, v18, v55
    v_swap_b32 v55, v12
    v_add_u32 v18, v18, v16
    v_sub_u32 v69, v18, v69
    v_swap_b32 v69, v13
    ds_write_b128 v5, v[10:13] offset:49408
    ds_read_b32 v70, v70 offset:49408
    ds_read_b32 v71, v71 offset:49408
    ds_read_b32 v72, v72 offset:49408
    ds_read_b32 v73, v73 offset:49408
    ds_read_b32 v74, v74 offset:49408
    ds_read_b32 v75, v75 offset:49408
    ds_read_b32 v76, v76 offset:49408
    ds_read_b32 v77, v77 offset:49408
    ds_read_b32 v78, v78 offset:49408
    ds_read_b32 v79, v79 offset:49408
    ds_read_b32 v80, v80 offset:49408
    ds_read_b32 v81, v81 offset:49408
    s_mov_b64 exec, s[36:37]
    s_cbranch_execz a_s13rz
    ds_read_b32 v82, v82 offset:49408
a_s13rz:
    s_mov_b64 exec, -1
    s_cmp_lt_u32 s3, 14
    s_cbranch_scc1 a_dutyBz
    s_cmp_lg_u32 s3, 15
    s_cbranch_scc1 a_dutyAz
    v_lshrrev_b32 v19, 2, v19
    v_mul_u32_u24 v19, 21846, v19
    v_lshrrev_b32 v19, 16, v19
    v_lshrrev_b32 v33, 2, v14
    v_mul_u32_u24 v33, 21846, v33
    v_lshrrev_b32 v33, 16, v33
    v_lshl_or_b32 v14, v33, 13, v19
    v_add_u32 v19, v19, v33
    v_lshrrev_b32 v33, 2, v15
    v_mul_u32_u24 v33, 21846, v33
    v_lshrrev_b32 v33, 16, v33
    v_lshl_or_b32 v15, v33, 13, v19
    v_add_u32 v19, v19, v33
    v_lshrrev_b32 v33, 2, v16
    v_mul_u32_u24 v33, 21846, v33
    v_lshrrev_b32 v33, 16, v33
    v_lshl_or_b32 v16, v33, 13, v19
    v_add_u32 v19, v19, v33
    v_lshrrev_b32 v33, 2, v17
    v_mul_u32_u24 v33, 21846, v33
    v_lshrrev_b32 v33, 16, v33
    v_lshl_or_b32 v17, v33, 13, v19
    v_add_u32 v19, v19, v33
    s_lshl_b32 s31, s94, 10
    v_add_u32 v19, s31, v5
    ds_write_b128 v19, v[14:17] offset:2560
a_dutyAz:
    s_cmp_lg_u32 s3, 14
    s_cbranch_scc1 a_dutyBz
    s_lshl_b32 s31, s2, 2
    s_add_u32 s31, s31, s94
    s_mul_i32 s31, s31, 260
    v_lshl_add_u32 v33, v5, 6, s31
    v_add_u32 v19, 0, v33
    v_and_b32 v19, 0xffff, v19
    v_or_b32 v19, 3211264, v19
    v_add_u32 v18, v10, v4
    v_and_b32 v14, 2, v18
    v_cmpx_eq_u32 vcc, 0, v14
    ds_write_b32 v18, v19 offset:50432
    ds_write_b16 v18, v14 offset:50430
    s_mov_b64 exec, -1
    v_add_u32 v19, 256, v33
    v_and_b32 v19, 0xffff, v19
    v_or_b32 v19, 3211264, v19
    v_add_u32 v18, v11, v9
    v_and_b32 v15, 2, v18
    v_cmpx_eq_u32 vcc, 0, v15
    ds_write_b32 v18, v19 offset:50432
    ds_write_b16 v18, v15 offset:50430
    s_mov_b64 exec, -1
    v_add_u32 v19, 512, v33
    v_and_b32 v19, 0xffff, v19
    v_or_b32 v19, 3211264, v19
    v_add_u32 v18, v12, v55
    v_and_b32 v16, 2, v18
    v_cmpx_eq_u32 vcc, 0, v16
    ds_write_b32 v18, v19 offset:50432
    ds_write_b16 v18, v16 offset:50430
    s_mov_b64 exec, -1
    v_add_u32 v19, 768, v33
    v_and_b32 v19, 0xffff, v19
    v_or_b32 v19, 3211264, v19
    v_add_u32 v18, v13, v69
    v_and_b32 v17, 2, v18
    v_cmpx_eq_u32 vcc, 0, v17
    ds_write_b32 v18, v19 offset:50432
    ds_write_b16 v18, v17 offset:50430
    s_mov_b64 exec, -1
a_dutyBz:
    s_waitcnt vmcnt(0)
    v_cmp_gt_i32 vcc, 0, v49
    s_cmp_eq_u64 vcc, -1
    s_cselect_b32 s40, 1, 0
    s_cbranch_scc0 a_shut0
    s_add_u32 s31, s60, 0
    s_mov_b32 s14, s61
    buffer_store_dwordx4 v[106:109], v83, s[12:15], s31 offen sc1
    s_add_u32 s31, s62, 16384
    s_mov_b32 s14, s63
    buffer_store_dwordx4 v[110:113], v83, s[12:15], s31 offen sc1
    s_add_u32 s31, s60, 32768
    s_mov_b32 s14, s61
    buffer_store_dwordx4 v[114:117], v83, s[12:15], s31 offen sc1
a_shut0:
    s_waitcnt lgkmcnt(0)
    v_add_u32 v84, v84, v70
    v_and_b32 v70, -4, v84
    v_sub_u32 v19, v84, v70
    v_lshl_add_u32 v84, v19, 1, v84
    ds_write_b32 v70, v56 offset:50432
    ds_write_b16 v84, v98 offset:50430
    v_add_u32 v85, v85, v71
    v_and_b32 v71, -4, v85
    v_sub_u32 v19, v85, v71
    v_lshl_add_u32 v85, v19, 1, v85
    ds_write_b32 v71, v57 offset:50432
    ds_write_b16_d16_hi v85, v98 offset:50430
    v_add_u32 v86, v86, v72
    v_and_b32 v72, -4, v86
    v_sub_u32 v19, v86, v72
    v_lshl_add_u32 v86, v19, 1, v86
    ds_write_b32 v72, v58 offset:50432
    ds_write_b16 v86, v99 offset:50430
    v_add_u32 v87, v87, v73
    v_and_b32 v73, -4, v87
    v_sub_u32 v19, v87, v73
    v_lshl_add_u32 v87, v19, 1, v87
    ds_write_b32 v73, v59 offset:50432
    ds_write_b16_d16_hi v87, v99 offset:50430
    v_add_u32 v88, v88, v74
    v_and_b32 v74, -4, v88
    v_sub_u32 v19, v88, v74
    v_lshl_add_u32 v88, v19, 1, v88
    ds_write_b32 v74, v60 offset:50432
    ds_write_b16 v88, v100 offset:50430
    v_add_u32 v89, v89, v75
    v_and_b32 v75, -4, v89
    v_sub_u32 v19, v89, v75
    v_lshl_add_u32 v89, v19, 1, v89
    ds_write_b32 v75, v61 offset:50432
    ds_write_b16_d16_hi v89, v100 offset:50430
    s_lshr_b32 s33, s3, 2
    s_lshl_b32 s33, s33, 6
    v_add_u32 v12, s33, v3
    v_mul_u32_u24 v10, 1311, v12
    v_mul_u32_u24 v126, 81920, v12
    v_lshrrev_b32 v10, 15, v10
    s_lshr_b32 s31, s35, 7
    v_xor_b32 v11, s31, v10
    v_mul_u32_u24 v10, 49152, v10
    v_and_b32 v11, 1, v11
    v_lshl_add_u32 v126, v11, 13, v126
    v_add_u32 v126, v126, v10
    s_mov_b32 s33, 131072
f_pollb0:
    v_cmp_gt_i32 vcc, 0, v48
    s_cmp_eq_u64 vcc, -1
    s_cbranch_scc1 f_polledb0
    s_sub_u32 s33, s33, 1
    s_cbranch_scc1 f_done
    s_cmp_ge_u32 s33, 131071
    s_cbranch_scc1 f_noslb0
    s_sleep 32
f_noslb0:
    s_lshl_b32 s31, s39, 18
    s_add_u32 s31, s31, s38
    buffer_load_dword v48, v5, s[8:11], s31 offen sc1
    s_waitcnt vmcnt(0)
    s_branch f_pollb0
f_polledb0:
    v_mov_b32 v10, 0
    v_mov_b32 v11, 0
    v_lshl_add_u32 v6, v3, 3, s48
    ds_write_b64 v6, v[10:11] offset:15104
    s_mul_i32 s33, s39, 25165824
    s_add_u32 s39, s39, 1
    v_add_u32 v13, s33, v126
    v_bfe_u32 v14, v48, 13, 13
    v_cmp_lt_u32 vcc, 0, v14
    v_mov_b32 v15, v14
    s_nop 0
    v_mbcnt_lo_u32_b32 v16, vcc_lo, 0
    v_mbcnt_hi_u32_b32 v16, vcc_hi, v16
    s_nop 1
    v_add_u32_dpp v15, v15, v15 row_shr:1 row_mask:0xf bank_mask:0xf
    s_nop 1
    v_add_u32_dpp v15, v15, v15 row_shr:2 row_mask:0xf bank_mask:0xf
    s_nop 1
    v_add_u32_dpp v15, v15, v15 row_shr:4 row_mask:0xf bank_mask:0xf
    s_nop 1
    v_add_u32_dpp v15, v15, v15 row_shr:8 row_mask:0xf bank_mask:0xf
    s_nop 1
    v_add_u32_dpp v15, v15, v15 row_bcast:15 row_mask:0xa bank_mask:0xf
    s_nop 1
    v_add_u32_dpp v15, v15, v15 row_bcast:31 row_mask:0xc bank_mask:0xf
    s_nop 0
    v_readlane_b32 s53, v15, 63
    v_sub_u32 v15, v15, v14
    v_and_b32 v48, 0x1fff, v48
    s_mul_i32 s57, s3, 66
    s_cmp_gt_u32 s53, 1792
    s_cselect_b32 s52, 1, s52
    s_cselect_b32 s53, 0, s53
    s_cbranch_scc1 f_nomap0
    v_sub_u32 v12, v48, v15
    v_add_lshl_u32 v10, v16, s57, 3
    v_cmpx_lt_u32 vcc, 0, v14
    ds_write_b64 v10, v[12:13] offset:6656
    v_add3_u32 v10, v15, v14, -1
    v_lshrrev_b32 v11, 3, v10
    v_and_b32 v11, -4, v11
    v_lshlrev_b32 v10, v10, 1
    v_add_u32 v11, s48, v11
    ds_or_b32 v11, v10 offset:15104
    s_mov_b64 exec, -1
f_nomap0:
    ds_read_b64 v[6:7], v6 offset:15104
    s_add_u32 s54, s53, 63
    s_lshr_b32 s54, s54, 6
    s_and_b32 s31, s3, 3
    s_mul_i32 s31, s31, s54
    s_lshr_b32 s32, s3, 2
    s_add_u32 s31, s31, s32
    s_lshr_b32 s58, s31, 2
    s_add_u32 s31, s31, s54
    s_lshr_b32 s44, s31, 2
    s_lshl_b32 s59, s58, 6
    v_add_u32 v15, v15, v14
    v_cmp_lt_u32 vcc, 0, v14
    v_cmp_ge_u32_e64 s[28:29], s59, v15
    s_and_b64 vcc, vcc, s[28:29]
    s_bcnt1_i32_b64 s31, vcc
    s_add_u32 s57, s57, s31
    s_cmp_eq_u32 s52, 0
    s_cbranch_scc1 f_nobad0
    v_mov_b32 v10, 0
    v_mov_b32 v11, -1
    ds_write_b32 v10, v11 offset:308
f_nobad0:
    s_lshl_b32 s32, s44, 6
    s_min_u32 s32, s32, s53
    s_sub_i32 s32, s32, s59
    v_cmp_gt_i32_e64 s[80:81], s32, v3
    s_sub_i32 s32, s32, 64
    v_cmp_gt_i32_e64 s[82:83], s32, v3
    s_sub_i32 s32, s32, 64
    v_cmp_gt_i32_e64 s[84:85], s32, v3
    s_sub_i32 s32, s32, 64
    v_cmp_gt_i32_e64 s[86:87], s32, v3
    s_sub_i32 s32, s32, 64
    v_cmp_gt_i32_e64 s[88:89], s32, v3
    s_sub_i32 s32, s32, 64
    v_cmp_gt_i32_e64 s[90:91], s32, v3
    s_sub_i32 s32, s32, 64
    v_cmp_gt_i32_e64 s[92:93], s32, v3
    s_waitcnt lgkmcnt(0)
    v_readlane_b32 s28, v6, s58
    v_readlane_b32 s29, v7, s58
    v_mov_b32 v23, 0x80000000
    s_add_u32 s58, s58, 1
    v_mbcnt_lo_u32_b32 v22, s28, 0
    v_mbcnt_hi_u32_b32 v22, s29, v22
    s_bcnt1_i32_b64 s31, s[28:29]
    v_add_lshl_u32 v22, v22, s57, 3
    s_add_u32 s57, s57, s31
    ds_read_b64 v[20:21], v22 offset:6656
    v_readlane_b32 s28, v6, s58
    v_readlane_b32 s29, v7, s58
    v_mov_b32 v27, 0x80000000
    s_add_u32 s58, s58, 1
    v_mbcnt_lo_u32_b32 v26, s28, 0
    v_mbcnt_hi_u32_b32 v26, s29, v26
    s_bcnt1_i32_b64 s31, s[28:29]
    v_add_lshl_u32 v26, v26, s57, 3
    s_add_u32 s57, s57, s31
    ds_read_b64 v[24:25], v26 offset:6656
    v_readlane_b32 s28, v6, s58
    v_readlane_b32 s29, v7, s58
    v_mov_b32 v31, 0x80000000
    s_add_u32 s58, s58, 1
    v_mbcnt_lo_u32_b32 v30, s28, 0
    v_mbcnt_hi_u32_b32 v30, s29, v30
    s_bcnt1_i32_b64 s31, s[28:29]
    v_add_lshl_u32 v30, v30, s57, 3
    s_add_u32 s57, s57, s31
    ds_read_b64 v[28:29], v30 offset:6656
    v_readlane_b32 s28, v6, s58
    v_readlane_b32 s29, v7, s58
    v_mov_b32 v35, 0x80000000
    s_add_u32 s58, s58, 1
    v_mbcnt_lo_u32_b32 v34, s28, 0
    v_mbcnt_hi_u32_b32 v34, s29, v34
    s_bcnt1_i32_b64 s31, s[28:29]
    v_add_lshl_u32 v34, v34, s57, 3
    s_add_u32 s57, s57, s31
    ds_read_b64 v[32:33], v34 offset:6656
    v_readlane_b32 s28, v6, s58
    v_readlane_b32 s29, v7, s58
    v_mov_b32 v39, 0x80000000
    s_add_u32 s58, s58, 1
    v_mbcnt_lo_u32_b32 v38, s28, 0
    v_mbcnt_hi_u32_b32 v38, s29, v38
    s_bcnt1_i32_b64 s31, s[28:29]
    v_add_lshl_u32 v38, v38, s57, 3
    s_add_u32 s57, s57, s31
    ds_read_b64 v[36:37], v38 offset:6656
    v_readlane_b32 s28, v6, s58
    v_readlane_b32 s29, v7, s58
    v_mov_b32 v43, 0x80000000
    s_add_u32 s58, s58, 1
    v_mbcnt_lo_u32_b32 v42, s28, 0
    v_mbcnt_hi_u32_b32 v42, s29, v42
    s_bcnt1_i32_b64 s31, s[28:29]
    v_add_lshl_u32 v42, v42, s57, 3
    s_add_u32 s57, s57, s31
    ds_read_b64 v[40:41], v42 offset:6656
    v_mov_b32 v47, 0x80000000
    s_cmp_eq_u64 s[92:93], 0
    s_cbranch_scc1 b_nod6a
    v_readlane_b32 s28, v6, s58
    v_readlane_b32 s29, v7, s58
    s_nop 0
    s_add_u32 s58, s58, 1
    v_mbcnt_lo_u32_b32 v46, s28, 0
    v_mbcnt_hi_u32_b32 v46, s29, v46
    s_bcnt1_i32_b64 s31, s[28:29]
    v_add_lshl_u32 v46, v46, s57, 3
    s_add_u32 s57, s57, s31
    ds_read_b64 v[44:45], v46 offset:6656
b_nod6a:
    s_cmp_eq_u32 s40, 0
    s_cbranch_scc1 a_shut1
    s_add_u32 s31, s62, 49152
    s_mov_b32 s14, s63
    buffer_store_dwordx4 v[118:121], v83, s[12:15], s31 offen sc1
    s_add_u32 s31, s60, 65536
    s_mov_b32 s14, s61
    buffer_store_dwordx4 v[122:125], v83, s[12:15], s31 offen sc1
    s_branch a_open1
a_shut1:
    s_lshl_b32 s31, s39, 18
    s_add_u32 s31, s31, s38
    buffer_load_dword v48, v5, s[8:11], s31 offen sc1
a_open1:
    v_add_u32 v90, v90, v76
    v_and_b32 v76, -4, v90
    v_sub_u32 v19, v90, v76
    v_lshl_add_u32 v90, v19, 1, v90
    ds_write_b32 v76, v62 offset:50432
    ds_write_b16 v90, v101 offset:50430
    v_add_u32 v91, v91, v77
    v_and_b32 v77, -4, v91
    v_sub_u32 v19, v91, v77
    v_lshl_add_u32 v91, v19, 1, v91
    ds_write_b32 v77, v63 offset:50432
    ds_write_b16_d16_hi v91, v101 offset:50430
    v_add_u32 v92, v92, v78
    v_and_b32 v78, -4, v92
    v_sub_u32 v19, v92, v78
    v_lshl_add_u32 v92, v19, 1, v92
    ds_write_b32 v78, v64 offset:50432
    ds_write_b16 v92, v102 offset:50430
    v_add_u32 v93, v93, v79
    v_and_b32 v79, -4, v93
    v_sub_u32 v19, v93, v79
    v_lshl_add_u32 v93, v19, 1, v93
    ds_write_b32 v79, v65 offset:50432
    ds_write_b16_d16_hi v93, v102 offset:50430
    v_add_u32 v94, v94, v80
    v_and_b32 v80, -4, v94
    v_sub_u32 v19, v94, v80
    v_lshl_add_u32 v94, v19, 1, v94
    ds_write_b32 v80, v66 offset:50432
    ds_write_b16 v94, v103 offset:50430
    v_add_u32 v95, v95, v81
    v_and_b32 v81, -4, v95
    v_sub_u32 v19, v95, v81
    v_lshl_add_u32 v95, v19, 1, v95
    ds_write_b32 v81, v67 offset:50432
    ds_write_b16_d16_hi v95, v103 offset:50430
    s_mov_b64 exec, s[36:37]
    s_cbranch_execz a_s13bz
    v_add_u32 v96, v96, v82
    v_and_b32 v82, -4, v96
    v_sub_u32 v19, v96, v82
    v_lshl_add_u32 v96, v19, 1, v96
    ds_write_b32 v82, v68 offset:50432
    ds_write_b16 v96, v104 offset:50430
a_s13bz:
    s_mov_b64 exec, -1
    s_cmp_lg_u32 s40, 0
    s_cbranch_scc1 a_open2
    s_waitcnt vmcnt(0)
    s_mov_b32 s33, 131072
f_pollgate:
    v_cmp_gt_i32 vcc, 0, v48
    s_cmp_eq_u64 vcc, -1
    s_cbranch_scc1 f_polledgate
    s_sub_u32 s33, s33, 1
    s_cbranch_scc1 f_done
    s_cmp_ge_u32 s33, 131072
    s_cbranch_scc1 f_noslgate
    s_sleep 32
f_noslgate:
    s_lshl_b32 s31, s39, 18
    s_add_u32 s31, s31, s38
    buffer_load_dword v48, v5, s[8:11], s31 offen sc1
    s_waitcnt vmcnt(0)
    s_branch f_pollgate
f_polledgate:
    s_add_u32 s31, s60, 0
    s_mov_b32 s14, s61
    buffer_store_dwordx4 v[106:109], v83, s[12:15], s31 offen sc1
    s_add_u32 s31, s62, 16384
    s_mov_b32 s14, s63
    buffer_store_dwordx4 v[110:113], v83, s[12:15], s31 offen sc1
    s_add_u32 s31, s60, 32768
    s_mov_b32 s14, s61
    buffer_store_dwordx4 v[114:117], v83, s[12:15], s31 offen sc1
    s_add_u32 s31, s62, 49152
    s_mov_b32 s14, s63
    buffer_store_dwordx4 v[118:121], v83, s[12:15], s31 offen sc1
    s_add_u32 s31, s60, 65536
    s_mov_b32 s14, s61
    buffer_store_dwordx4 v[122:125], v83, s[12:15], s31 offen sc1
a_open2:
    s_waitcnt lgkmcnt(0)
    s_mov_b64 exec, s[80:81]
    s_add_u32 s31, s59, 0
    v_add3_u32 v20, v20, v3, s31
    v_mul_hi_u32_u24 v22, 0x606061, v20
    v_mad_u32_u24 v20, v20, 12, v21
    v_mad_u32_u24 v23, v22, s51, v20
    s_mov_b64 exec, -1
    buffer_load_dwordx3 v[20:22], v23, s[8:11], 0 offen sc1
    s_mov_b64 exec, s[82:83]
    s_add_u32 s31, s59, 64
    v_add3_u32 v24, v24, v3, s31
    v_mul_hi_u32_u24 v26, 0x606061, v24
    v_mad_u32_u24 v24, v24, 12, v25
    v_mad_u32_u24 v27, v26, s51, v24
    s_mov_b64 exec, -1
    buffer_load_dwordx3 v[24:26], v27, s[8:11], 0 offen sc1
    s_mov_b64 exec, s[84:85]
    s_add_u32 s31, s59, 128
    v_add3_u32 v28, v28, v3, s31
    v_mul_hi_u32_u24 v30, 0x606061, v28
    v_mad_u32_u24 v28, v28, 12, v29
    v_mad_u32_u24 v31, v30, s51, v28
    s_mov_b64 exec, -1
    buffer_load_dwordx3 v[28:30], v31, s[8:11], 0 offen sc1
    s_barrier
    s_mov_b64 exec, s[86:87]
    s_add_u32 s31, s59, 192
    v_add3_u32 v32, v32, v3, s31
    v_mul_hi_u32_u24 v34, 0x606061, v32
    v_mad_u32_u24 v32, v32, 12, v33
    v_mad_u32_u24 v35, v34, s51, v32
    s_mov_b64 exec, -1
    buffer_load_dwordx3 v[32:34], v35, s[8:11], 0 offen sc1
    s_mov_b64 exec, s[88:89]
    s_add_u32 s31, s59, 256
    v_add3_u32 v36, v36, v3, s31
    v_mul_hi_u32_u24 v38, 0x606061, v36
    v_mad_u32_u24 v36, v36, 12, v37
    v_mad_u32_u24 v39, v38, s51, v36
    s_mov_b64 exec, -1
    buffer_load_dwordx3 v[36:38], v39, s[8:11], 0 offen sc1
    s_mov_b64 exec, s[90:91]
    s_add_u32 s31, s59, 320
    v_add3_u32 v40, v40, v3, s31
    v_mul_hi_u32_u24 v42, 0x606061, v40
    v_mad_u32_u24 v40, v40, 12, v41
    v_mad_u32_u24 v43, v42, s51, v40
    s_mov_b64 exec, -1
    buffer_load_dwordx3 v[40:42], v43, s[8:11], 0 offen sc1
    s_mov_b64 exec, s[92:93]
    s_cbranch_execz b_nol6a
    s_add_u32 s31, s59, 384
    v_add3_u32 v44, v44, v3, s31
    v_mul_hi_u32_u24 v46, 0x606061, v44
    v_mad_u32_u24 v44, v44, 12, v45
    v_mad_u32_u24 v47, v46, s51, v44
b_nol6a:
    s_mov_b64 exec, -1
    buffer_load_dwordx3 v[44:46], v47, s[8:11], 0 offen sc1
    s_max_u32 s31, s64, s47
    s_cmp_gt_u32 s31, 40800
    s_cselect_b32 s65, -1, s65
    s_cmp_eq_u32 s45, 0
    s_cselect_b32 s61, s64, s47
    s_cselect_b32 s63, s47, s64
    s_mov_b32 s60, s30
    s_xor_b32 s62, s60, 0x2000
    s_min_u32 s61, s61, 40800
    s_mul_i32 s31, s61, 32897
    s_lshr_b32 s31, s31, 28
    s_mul_i32 s31, s31, 8224
    s_add_u32 s61, s61, s31
    s_add_u32 s61, s61, 127
    s_and_b32 s61, s61, 0xffffff80
    s_add_u32 s61, s61, s60
    s_min_u32 s63, s63, 40800
    s_mul_i32 s31, s63, 32897
    s_lshr_b32 s31, s31, 28
    s_mul_i32 s31, s31, 8224
    s_add_u32 s63, s63, s31
    s_add_u32 s63, s63, 127
    s_and_b32 s63, s63, 0xffffff80
    s_add_u32 s63, s63, s62
    s_add_u32 s30, s30, 25165824
    v_mov_b32 v2, v8
    v_mov_b32 v1, v105
    v_lshlrev_b32 v19, 4, v0
    v_bfe_u32 v12, v0, 5, 1
    v_and_b32 v19, 0x1fff, v19
    v_mul_u32_u24 v18, 57344, v12
    v_mov_b32 v4, 8
    s_lshr_b32 s31, s2, 4
    s_and_b32 s32, s2, 15
    s_mul_i32 s30, s32, 114688
    s_xor_b32 s32, s31, s45
    s_and_b32 s32, s32, 1
    s_lshl_b32 s32, s32, 13
    s_add_u32 s30, s30, s32
    s_add_u32 s31, s31, 48
    s_lshl_b32 s31, s31, 21
    s_add_u32 s30, s30, s31
    s_mov_b32 s94, 0
    v_mov_b32 v120, 0
    v_mov_b32 v121, 0
    v_mov_b32 v122, 0
    v_mov_b32 v123, 0
    s_mov_b32 s14, 0
    buffer_store_dword v19, v19, s[12:15], 0 offen
    buffer_store_dword v19, v19, s[12:15], 0 offen
    buffer_store_dword v19, v19, s[12:15], 0 offen
    buffer_store_dword v19, v19, s[12:15], 0 offen
b_loop:
    s_mov_b64 s[66:67], s[80:81]
    s_mov_b64 s[68:69], s[82:83]
    s_mov_b64 s[70:71], s[84:85]
    s_mov_b64 s[72:73], s[86:87]
    s_mov_b64 s[74:75], s[88:89]
    s_mov_b64 s[76:77], s[90:91]
    s_mov_b64 s[78:79], s[92:93]
    s_cmp_lg_u32 s94, 2
    s_cbranch_scc1 b_notouch
    s_getpc_b64 s[16:17]
f_pc3:
    s_mov_b32 s18, c_fallback - f_pc3
    s_mov_b32 s19, 0x00020000
    v_lshlrev_b32 v17, 7, v0
    buffer_load_dword v17, v17, s[16:19], 0 offen
b_notouch:
    s_lshl_b32 s31, s39, 18
    s_add_u32 s31, s31, s38
    buffer_load_dword v16, v5, s[8:11], s31 offen sc1
    s_cmp_eq_u32 s94, 0
    s_cbranch_scc1 b_altra
    ds_read_b128 v[104:107], v2 offset:0
    ds_read_b128 v[108:111], v1 offset:8192
    ds_read_b128 v[112:115], v2 offset:49152
    ds_read_b128 v[116:119], v2 offset:16384
    s_branch b_endra
b_altra:
    ds_read_b128 v[104:107], v2 offset:0
    ds_read_b128 v[108:111], v1 offset:8160
    ds_read_b128 v[116:119], v2 offset:16320
b_endra:
    s_waitcnt vmcnt(11)
    v_alignbit_b32 v124, v20, v20, 19
    v_and_b32 v124, 0x7ff8, v124
    ds_read_b64 v[48:49], v124 offset:23296
    v_alignbit_b32 v125, v22, v22, 19
    v_and_b32 v125, 0x7ff8, v125
    ds_read_b64 v[50:51], v125 offset:23296
    s_waitcnt vmcnt(10)
    v_alignbit_b32 v124, v24, v24, 19
    v_and_b32 v124, 0x7ff8, v124
    ds_read_b64 v[52:53], v124 offset:23296
    v_alignbit_b32 v125, v26, v26, 19
    v_and_b32 v125, 0x7ff8, v125
    ds_read_b64 v[54:55], v125 offset:23296
    s_waitcnt vmcnt(9)
    v_alignbit_b32 v124, v28, v28, 19
    v_and_b32 v124, 0x7ff8, v124
    ds_read_b64 v[56:57], v124 offset:23296
    v_alignbit_b32 v125, v30, v30, 19
    v_and_b32 v125, 0x7ff8, v125
    ds_read_b64 v[58:59], v125 offset:23296
    s_waitcnt lgkmcnt(0)
    s_mov_b64 exec, s[66:67]
    v_lshlrev_b32_sdwa v76, 2, v20 dst_sel:DWORD dst_unused:UNUSED_PAD src0_sel:DWORD src1_sel:BYTE_1
    ds_add_rtn_u32 v90, v76, v4 offset:512
    v_lshlrev_b32_sdwa v77, 2, v22 dst_sel:DWORD dst_unused:UNUSED_PAD src0_sel:DWORD src1_sel:BYTE_1
    ds_add_rtn_u32 v91, v77, v4 offset:512
    s_mov_b64 exec, s[68:69]
    v_lshlrev_b32_sdwa v78, 2, v24 dst_sel:DWORD dst_unused:UNUSED_PAD src0_sel:DWORD src1_sel:BYTE_1
    ds_add_rtn_u32 v92, v78, v4 offset:512
    v_lshlrev_b32_sdwa v79, 2, v26 dst_sel:DWORD dst_unused:UNUSED_PAD src0_sel:DWORD src1_sel:BYTE_1
    ds_add_rtn_u32 v93, v79, v4 offset:512
    s_mov_b64 exec, s[70:71]
    v_lshlrev_b32_sdwa v80, 2, v28 dst_sel:DWORD dst_unused:UNUSED_PAD src0_sel:DWORD src1_sel:BYTE_1
    ds_add_rtn_u32 v94, v80, v4 offset:512
    v_lshlrev_b32_sdwa v81, 2, v30 dst_sel:DWORD dst_unused:UNUSED_PAD src0_sel:DWORD src1_sel:BYTE_1
    ds_add_rtn_u32 v95, v81, v4 offset:512
    s_mov_b64 exec, -1
    s_add_u32 s31, s60, 0
    s_mov_b32 s14, s61
    buffer_store_dwordx4 v[104:107], v19, s[12:15], s31 offen sc1
    s_add_u32 s31, s62, 16384
    s_mov_b32 s14, s63
    buffer_store_dwordx4 v[108:111], v19, s[12:15], s31 offen sc1
    v_pk_mul_f16 v48, v48, v21 op_sel:[0,0] op_sel_hi:[1,0]
    v_pk_mul_f16 v49, v49, v21 op_sel:[0,0] op_sel_hi:[1,0]
    v_pk_lshrrev_b16 v124, s56, v20
    v_pk_lshrrev_b16 v20, s50, v20
    v_add_u32 v48, 0x40004, v48
    v_add_u32 v49, 0x40004, v49
    v_bfi_b32 v48, s49, v20, v48
    v_bfi_b32 v49, s49, v124, v49
    v_pk_mul_f16 v50, v50, v21 op_sel:[0,1] op_sel_hi:[1,1]
    v_pk_mul_f16 v51, v51, v21 op_sel:[0,1] op_sel_hi:[1,1]
    v_pk_lshrrev_b16 v124, s56, v22
    v_pk_lshrrev_b16 v22, s50, v22
    v_add_u32 v50, 0x40004, v50
    v_add_u32 v51, 0x40004, v51
    v_bfi_b32 v50, s49, v22, v50
    v_bfi_b32 v51, s49, v124, v51
    s_waitcnt vmcnt(7)
    s_mov_b64 exec, s[72:73]
    v_lshlrev_b32_sdwa v82, 2, v32 dst_sel:DWORD dst_unused:UNUSED_PAD src0_sel:DWORD src1_sel:BYTE_1
    ds_add_rtn_u32 v96, v82, v4 offset:512
    v_lshlrev_b32_sdwa v83, 2, v34 dst_sel:DWORD dst_unused:UNUSED_PAD src0_sel:DWORD src1_sel:BYTE_1
    ds_add_rtn_u32 v97, v83, v4 offset:512
    s_mov_b64 exec, -1
    v_pk_mul_f16 v52, v52, v25 op_sel:[0,0] op_sel_hi:[1,0]
    v_pk_mul_f16 v53, v53, v25 op_sel:[0,0] op_sel_hi:[1,0]
    v_pk_lshrrev_b16 v124, s56, v24
    v_pk_lshrrev_b16 v24, s50, v24
    v_add_u32 v52, 0x40004, v52
    v_add_u32 v53, 0x40004, v53
    v_bfi_b32 v52, s49, v24, v52
    v_bfi_b32 v53, s49, v124, v53
    v_pk_mul_f16 v54, v54, v25 op_sel:[0,1] op_sel_hi:[1,1]
    v_pk_mul_f16 v55, v55, v25 op_sel:[0,1] op_sel_hi:[1,1]
    v_pk_lshrrev_b16 v124, s56, v26
    v_pk_lshrrev_b16 v26, s50, v26
    v_add_u32 v54, 0x40004, v54
    v_add_u32 v55, 0x40004, v55
    v_bfi_b32 v54, s49, v26, v54
    v_bfi_b32 v55, s49, v124, v55
    s_waitcnt vmcnt(6)
    s_mov_b64 exec, s[74:75]
    v_lshlrev_b32_sdwa v84, 2, v36 dst_sel:DWORD dst_unused:UNUSED_PAD src0_sel:DWORD src1_sel:BYTE_1
    ds_add_rtn_u32 v98, v84, v4 offset:512
    v_lshlrev_b32_sdwa v85, 2, v38 dst_sel:DWORD dst_unused:UNUSED_PAD src0_sel:DWORD src1_sel:BYTE_1
    ds_add_rtn_u32 v99, v85, v4 offset:512
    s_mov_b64 exec, -1
    s_add_u32 s31, s60, 98304
    s_mov_b32 s14, s61
    buffer_store_dwordx4 v[112:115], v19, s[12:15], s31 offen sc1
    v_pk_mul_f16 v56, v56, v29 op_sel:[0,0] op_sel_hi:[1,0]
    v_pk_mul_f16 v57, v57, v29 op_sel:[0,0] op_sel_hi:[1,0]
    v_pk_lshrrev_b16 v124, s56, v28
    v_pk_lshrrev_b16 v28, s50, v28
    v_add_u32 v56, 0x40004, v56
    v_add_u32 v57, 0x40004, v57
    v_bfi_b32 v56, s49, v28, v56
    v_bfi_b32 v57, s49, v124, v57
    v_pk_mul_f16 v58, v58, v29 op_sel:[0,1] op_sel_hi:[1,1]
    v_pk_mul_f16 v59, v59, v29 op_sel:[0,1] op_sel_hi:[1,1]
    v_pk_lshrrev_b16 v124, s56, v30
    v_pk_lshrrev_b16 v30, s50, v30
    v_add_u32 v58, 0x40004, v58
    v_add_u32 v59, 0x40004, v59
    v_bfi_b32 v58, s49, v30, v58
    v_bfi_b32 v59, s49, v124, v59
    s_waitcnt vmcnt(3)
    s_mov_b32 s33, 131072
f_pollb1l:
    v_cmp_gt_i32 vcc, 0, v16
    s_cmp_eq_u64 vcc, -1
    s_cbranch_scc1 f_polledb1l
    s_sub_u32 s33, s33, 1
    s_cbranch_scc1 f_done
    s_cmp_ge_u32 s33, 131071
    s_cbranch_scc1 f_noslb1l
    s_sleep 32
f_noslb1l:
    s_lshl_b32 s31, s39, 18
    s_add_u32 s31, s31, s38
    buffer_load_dword v16, v5, s[8:11], s31 offen sc1
    s_waitcnt vmcnt(0)
    s_branch f_pollb1l
f_polledb1l:
    v_mov_b32 v8, 0
    v_mov_b32 v9, 0
    v_lshl_add_u32 v6, v3, 3, s48
    ds_write_b64 v6, v[8:9] offset:15104
    s_mul_i32 s33, s39, 25165824
    s_add_u32 s39, s39, 1
    v_add_u32 v11, s33, v126
    v_bfe_u32 v12, v16, 13, 13
    v_cmp_lt_u32 vcc, 0, v12
    v_mov_b32 v13, v12
    s_nop 0
    v_mbcnt_lo_u32_b32 v14, vcc_lo, 0
    v_mbcnt_hi_u32_b32 v14, vcc_hi, v14
    s_nop 1
    v_add_u32_dpp v13, v13, v13 row_shr:1 row_mask:0xf bank_mask:0xf
    s_nop 1
    v_add_u32_dpp v13, v13, v13 row_shr:2 row_mask:0xf bank_mask:0xf
    s_nop 1
    v_add_u32_dpp v13, v13, v13 row_shr:4 row_mask:0xf bank_mask:0xf
    s_nop 1
    v_add_u32_dpp v13, v13, v13 row_shr:8 row_mask:0xf bank_mask:0xf
    s_nop 1
    v_add_u32_dpp v13, v13, v13 row_bcast:15 row_mask:0xa bank_mask:0xf
    s_nop 1
    v_add_u32_dpp v13, v13, v13 row_bcast:31 row_mask:0xc bank_mask:0xf
    s_nop 0
    v_readlane_b32 s53, v13, 63
    v_sub_u32 v13, v13, v12
    v_and_b32 v16, 0x1fff, v16
    s_mul_i32 s57, s3, 66
    s_cmp_gt_u32 s53, 1792
    s_cselect_b32 s52, 1, s52
    s_cselect_b32 s53, 0, s53
    s_cbranch_scc1 f_nomap1l
    v_sub_u32 v10, v16, v13
    v_add_lshl_u32 v8, v14, s57, 3
    v_cmpx_lt_u32 vcc, 0, v12
    ds_write_b64 v8, v[10:11] offset:6656
    v_add3_u32 v8, v13, v12, -1
    v_lshrrev_b32 v9, 3, v8
    v_and_b32 v9, -4, v9
    v_lshlrev_b32 v8, v8, 1
    v_add_u32 v9, s48, v9
    ds_or_b32 v9, v8 offset:15104
    s_mov_b64 exec, -1
f_nomap1l:
    ds_read_b64 v[6:7], v6 offset:15104
    s_add_u32 s54, s53, 63
    s_lshr_b32 s54, s54, 6
    s_and_b32 s31, s3, 3
    s_mul_i32 s31, s31, s54
    s_lshr_b32 s32, s3, 2
    s_add_u32 s31, s31, s32
    s_lshr_b32 s58, s31, 2
    s_add_u32 s31, s31, s54
    s_lshr_b32 s44, s31, 2
    s_lshl_b32 s59, s58, 6
    v_add_u32 v13, v13, v12
    v_cmp_lt_u32 vcc, 0, v12
    v_cmp_ge_u32_e64 s[28:29], s59, v13
    s_and_b64 vcc, vcc, s[28:29]
    s_bcnt1_i32_b64 s31, vcc
    s_add_u32 s57, s57, s31
    s_cmp_eq_u32 s52, 0
    s_cbranch_scc1 f_nobad1l
    v_mov_b32 v8, 0
    v_mov_b32 v9, -1
    ds_write_b32 v8, v9 offset:308
f_nobad1l:
    s_lshl_b32 s32, s44, 6
    s_min_u32 s32, s32, s53
    s_sub_i32 s32, s32, s59
    v_cmp_gt_i32_e64 s[80:81], s32, v3
    s_sub_i32 s32, s32, 64
    v_cmp_gt_i32_e64 s[82:83], s32, v3
    s_sub_i32 s32, s32, 64
    v_cmp_gt_i32_e64 s[84:85], s32, v3
    s_sub_i32 s32, s32, 64
    v_cmp_gt_i32_e64 s[86:87], s32, v3
    s_sub_i32 s32, s32, 64
    v_cmp_gt_i32_e64 s[88:89], s32, v3
    s_sub_i32 s32, s32, 64
    v_cmp_gt_i32_e64 s[90:91], s32, v3
    s_sub_i32 s32, s32, 64
    v_cmp_gt_i32_e64 s[92:93], s32, v3
    s_waitcnt lgkmcnt(0)
    v_readlane_b32 s28, v6, s58
    v_readlane_b32 s29, v7, s58
    v_mov_b32 v23, 0x80000000
    s_add_u32 s58, s58, 1
    v_mbcnt_lo_u32_b32 v22, s28, 0
    v_mbcnt_hi_u32_b32 v22, s29, v22
    s_bcnt1_i32_b64 s31, s[28:29]
    v_add_lshl_u32 v22, v22, s57, 3
    s_add_u32 s57, s57, s31
    ds_read_b64 v[20:21], v22 offset:6656
    v_readlane_b32 s28, v6, s58
    v_readlane_b32 s29, v7, s58
    v_mov_b32 v27, 0x80000000
    s_add_u32 s58, s58, 1
    v_mbcnt_lo_u32_b32 v26, s28, 0
    v_mbcnt_hi_u32_b32 v26, s29, v26
    s_bcnt1_i32_b64 s31, s[28:29]
    v_add_lshl_u32 v26, v26, s57, 3
    s_add_u32 s57, s57, s31
    ds_read_b64 v[24:25], v26 offset:6656
    v_readlane_b32 s28, v6, s58
    v_readlane_b32 s29, v7, s58
    v_mov_b32 v31, 0x80000000
    s_add_u32 s58, s58, 1
    v_mbcnt_lo_u32_b32 v30, s28, 0
    v_mbcnt_hi_u32_b32 v30, s29, v30
    s_bcnt1_i32_b64 s31, s[28:29]
    v_add_lshl_u32 v30, v30, s57, 3
    s_add_u32 s57, s57, s31
    ds_read_b64 v[28:29], v30 offset:6656
    s_cmp_eq_u32 s94, 0
    s_cbranch_scc1 b_altrb
    ds_read_b128 v[104:107], v1 offset:24576
    ds_read_b128 v[108:111], v2 offset:32768
    ds_read_b128 v[112:115], v1 offset:40960
    s_branch b_endrb
b_altrb:
    ds_read_b128 v[104:107], v1 offset:24480
    ds_read_b128 v[108:111], v2 offset:32640
    v_lshrrev_b32 v124, 9, v0
    v_mul_u32_u24 v124, 57344, v124
    v_add_u32 v2, v19, v124
    v_sub_u32 v1, v19, v124
    v_add_u32 v2, 48384, v2
    v_add_u32 v1, 105728, v1
b_endrb:
    s_mov_b64 exec, s[76:77]
    v_lshlrev_b32_sdwa v86, 2, v40 dst_sel:DWORD dst_unused:UNUSED_PAD src0_sel:DWORD src1_sel:BYTE_1
    ds_add_rtn_u32 v100, v86, v4 offset:512
    v_lshlrev_b32_sdwa v87, 2, v42 dst_sel:DWORD dst_unused:UNUSED_PAD src0_sel:DWORD src1_sel:BYTE_1
    ds_add_rtn_u32 v101, v87, v4 offset:512
    s_mov_b64 exec, s[78:79]
    s_cbranch_execz b_k6l
    v_lshlrev_b32_sdwa v88, 2, v44 dst_sel:DWORD dst_unused:UNUSED_PAD src0_sel:DWORD src1_sel:BYTE_1
    ds_add_rtn_u32 v102, v88, v4 offset:512
    v_lshlrev_b32_sdwa v89, 2, v46 dst_sel:DWORD dst_unused:UNUSED_PAD src0_sel:DWORD src1_sel:BYTE_1
    ds_add_rtn_u32 v103, v89, v4 offset:512
b_k6l:
    s_waitcnt lgkmcnt(0)
    s_mov_b64 exec, -1
    s_mov_b64 exec, s[80:81]
    s_add_u32 s31, s59, 0
    v_add3_u32 v20, v20, v3, s31
    v_mul_hi_u32_u24 v22, 0x606061, v20
    v_mad_u32_u24 v20, v20, 12, v21
    v_mad_u32_u24 v23, v22, s51, v20
    s_mov_b64 exec, -1
    buffer_load_dwordx3 v[20:22], v23, s[8:11], 0 offen sc1
    s_mov_b64 exec, s[82:83]
    s_add_u32 s31, s59, 64
    v_add3_u32 v24, v24, v3, s31
    v_mul_hi_u32_u24 v26, 0x606061, v24
    v_mad_u32_u24 v24, v24, 12, v25
    v_mad_u32_u24 v27, v26, s51, v24
    s_mov_b64 exec, -1
    buffer_load_dwordx3 v[24:26], v27, s[8:11], 0 offen sc1
    s_mov_b64 exec, s[84:85]
    s_add_u32 s31, s59, 128
    v_add3_u32 v28, v28, v3, s31
    v_mul_hi_u32_u24 v30, 0x606061, v28
    v_mad_u32_u24 v28, v28, 12, v29
    v_mad_u32_u24 v31, v30, s51, v28
    s_mov_b64 exec, -1
    buffer_load_dwordx3 v[28:30], v31, s[8:11], 0 offen sc1
    s_waitcnt vmcnt(7)
    s_barrier
    s_cmp_lg_u32 s3, 2
    s_cbranch_scc1 b_norowl
    s_add_u32 s47, s94, 2
    s_and_b32 s31, s47, 3
    s_lshl_b32 s31, s31, 10
    v_add_u32 v8, s31, v5
    v_mov_b32 v12, 0
    ds_read_b128 v[8:11], v8 offset:2560
    ds_read_b32 v12, v12 offset:308
    s_lshl_b32 s31, s47, 18
    s_lshl_b32 s33, s2, 4
    s_add_u32 s31, s31, s33
    s_add_u32 s31, s31, 234881024
    s_or_b32 s32, s65, 0x80000000
    s_waitcnt lgkmcnt(0)
    v_or3_b32 v8, v8, s32, v12
    v_or3_b32 v9, v9, s32, v12
    v_or3_b32 v10, v10, s32, v12
    v_or3_b32 v11, v11, s32, v12
    v_lshlrev_b32 v12, 8, v5
    buffer_store_dwordx4 v[8:11], v12, s[8:11], s31 offen sc1
    s_nop 1
b_norowl:
    ds_read_b128 v[8:11], v5 offset:512
    v_alignbit_b32 v124, v32, v32, 19
    v_and_b32 v124, 0x7ff8, v124
    ds_read_b64 v[60:61], v124 offset:23296
    v_alignbit_b32 v125, v34, v34, 19
    v_and_b32 v125, 0x7ff8, v125
    ds_read_b64 v[62:63], v125 offset:23296
    v_alignbit_b32 v124, v36, v36, 19
    v_and_b32 v124, 0x7ff8, v124
    ds_read_b64 v[64:65], v124 offset:23296
    v_alignbit_b32 v125, v38, v38, 19
    v_and_b32 v125, 0x7ff8, v125
    ds_read_b64 v[66:67], v125 offset:23296
    v_alignbit_b32 v124, v40, v40, 19
    v_and_b32 v124, 0x7ff8, v124
    ds_read_b64 v[68:69], v124 offset:23296
    v_alignbit_b32 v125, v42, v42, 19
    v_and_b32 v125, 0x7ff8, v125
    ds_read_b64 v[70:71], v125 offset:23296
    s_cmp_eq_u64 s[78:79], 0
    s_cbranch_scc1 b_g6l
    v_alignbit_b32 v124, v44, v44, 19
    v_and_b32 v124, 0x7ff8, v124
    ds_read_b64 v[72:73], v124 offset:23296
    v_alignbit_b32 v125, v46, v46, 19
    v_and_b32 v125, 0x7ff8, v125
    ds_read_b64 v[74:75], v125 offset:23296
b_g6l:
    s_waitcnt lgkmcnt(6)
    s_add_u32 s31, s60, 32768
    s_mov_b32 s14, s61
    buffer_store_dwordx4 v[116:119], v19, s[12:15], s31 offen sc1
    v_sub_u32 v12, v8, v120
    v_add_u32 v12, 8, v12
    v_sub_u32 v13, v9, v121
    v_add_u32 v13, 8, v13
    v_sub_u32 v14, v10, v122
    v_add_u32 v14, 8, v14
    v_sub_u32 v15, v11, v123
    v_add_u32 v15, 8, v15
    v_and_b32 v12, -16, v12
    v_and_b32 v13, -16, v13
    v_and_b32 v14, -16, v14
    v_and_b32 v15, -16, v15
    v_add_u32 v17, v12, v13
    v_add3_u32 v17, v17, v14, v15
    v_mov_b32 v16, v17
    s_nop 1
    v_add_u32_dpp v16, v16, v16 row_shr:1 row_mask:0xf bank_mask:0xf
    s_nop 1
    v_add_u32_dpp v16, v16, v16 row_shr:2 row_mask:0xf bank_mask:0xf
    s_nop 1
    v_add_u32_dpp v16, v16, v16 row_shr:4 row_mask:0xf bank_mask:0xf
    s_nop 1
    v_add_u32_dpp v16, v16, v16 row_shr:8 row_mask:0xf bank_mask:0xf
    s_nop 1
    v_add_u32_dpp v16, v16, v16 row_bcast:15 row_mask:0xa bank_mask:0xf
    v_sub_u32 v17, v16, v17
    v_readlane_b32 s64, v16, 31
    v_readlane_b32 s47, v16, 63
    v_add_u32 v16, v17, v18
    v_sub_u32 v120, v16, v120
    v_swap_b32 v120, v8
    v_add_u32 v16, v16, v12
    v_sub_u32 v121, v16, v121
    v_swap_b32 v121, v9
    v_add_u32 v16, v16, v13
    v_sub_u32 v122, v16, v122
    v_swap_b32 v122, v10
    v_add_u32 v16, v16, v14
    v_sub_u32 v123, v16, v123
    v_swap_b32 v123, v11
    s_waitcnt lgkmcnt(0)
    ds_write_b128 v5, v[8:11] offset:1536
    s_mov_b64 exec, s[66:67]
    ds_read_b32 v76, v76 offset:1536
    ds_read_b32 v77, v77 offset:1536
    s_mov_b64 exec, s[68:69]
    ds_read_b32 v78, v78 offset:1536
    ds_read_b32 v79, v79 offset:1536
    s_mov_b64 exec, s[70:71]
    ds_read_b32 v80, v80 offset:1536
    ds_read_b32 v81, v81 offset:1536
    s_mov_b64 exec, s[72:73]
    ds_read_b32 v82, v82 offset:1536
    ds_read_b32 v83, v83 offset:1536
    s_mov_b64 exec, s[74:75]
    ds_read_b32 v84, v84 offset:1536
    ds_read_b32 v85, v85 offset:1536
    s_mov_b64 exec, s[76:77]
    ds_read_b32 v86, v86 offset:1536
    ds_read_b32 v87, v87 offset:1536
    s_mov_b64 exec, s[78:79]
    s_cbranch_execz b_b6l
    ds_read_b32 v88, v88 offset:1536
    ds_read_b32 v89, v89 offset:1536
b_b6l:
    s_mov_b64 exec, -1
    s_add_u32 s31, s62, 49152
    s_mov_b32 s14, s63
    buffer_store_dwordx4 v[104:107], v19, s[12:15], s31 offen sc1
    v_pk_mul_f16 v60, v60, v33 op_sel:[0,0] op_sel_hi:[1,0]
    v_pk_mul_f16 v61, v61, v33 op_sel:[0,0] op_sel_hi:[1,0]
    v_pk_lshrrev_b16 v124, s56, v32
    v_pk_lshrrev_b16 v32, s50, v32
    v_add_u32 v60, 0x40004, v60
    v_add_u32 v61, 0x40004, v61
    v_bfi_b32 v60, s49, v32, v60
    v_bfi_b32 v61, s49, v124, v61
    v_pk_mul_f16 v62, v62, v33 op_sel:[0,1] op_sel_hi:[1,1]
    v_pk_mul_f16 v63, v63, v33 op_sel:[0,1] op_sel_hi:[1,1]
    v_pk_lshrrev_b16 v124, s56, v34
    v_pk_lshrrev_b16 v34, s50, v34
    v_add_u32 v62, 0x40004, v62
    v_add_u32 v63, 0x40004, v63
    v_bfi_b32 v62, s49, v34, v62
    v_bfi_b32 v63, s49, v124, v63
    v_pk_mul_f16 v64, v64, v37 op_sel:[0,0] op_sel_hi:[1,0]
    v_pk_mul_f16 v65, v65, v37 op_sel:[0,0] op_sel_hi:[1,0]
    v_pk_lshrrev_b16 v124, s56, v36
    v_pk_lshrrev_b16 v36, s50, v36
    v_add_u32 v64, 0x40004, v64
    v_add_u32 v65, 0x40004, v65
    v_bfi_b32 v64, s49, v36, v64
    v_bfi_b32 v65, s49, v124, v65
    v_pk_mul_f16 v66, v66, v37 op_sel:[0,1] op_sel_hi:[1,1]
    v_pk_mul_f16 v67, v67, v37 op_sel:[0,1] op_sel_hi:[1,1]
    v_pk_lshrrev_b16 v124, s56, v38
    v_pk_lshrrev_b16 v38, s50, v38
    v_add_u32 v66, 0x40004, v66
    v_add_u32 v67, 0x40004, v67
    v_bfi_b32 v66, s49, v38, v66
    v_bfi_b32 v67, s49, v124, v67
    s_add_u32 s31, s60, 65536
    s_mov_b32 s14, s61
    buffer_store_dwordx4 v[108:111], v19, s[12:15], s31 offen sc1
    v_pk_mul_f16 v68, v68, v41 op_sel:[0,0] op_sel_hi:[1,0]
    v_pk_mul_f16 v69, v69, v41 op_sel:[0,0] op_sel_hi:[1,0]
    v_pk_lshrrev_b16 v124, s56, v40
    v_pk_lshrrev_b16 v40, s50, v40
    v_add_u32 v68, 0x40004, v68
    v_add_u32 v69, 0x40004, v69
    v_bfi_b32 v68, s49, v40, v68
    v_bfi_b32 v69, s49, v124, v69
    v_pk_mul_f16 v70, v70, v41 op_sel:[0,1] op_sel_hi:[1,1]
    v_pk_mul_f16 v71, v71, v41 op_sel:[0,1] op_sel_hi:[1,1]
    v_pk_lshrrev_b16 v124, s56, v42
    v_pk_lshrrev_b16 v42, s50, v42
    v_add_u32 v70, 0x40004, v70
    v_add_u32 v71, 0x40004, v71
    v_bfi_b32 v70, s49, v42, v70
    v_bfi_b32 v71, s49, v124, v71
    s_cmp_eq_u64 s[78:79], 0
    s_cbranch_scc1 b_r6l
    v_pk_mul_f16 v72, v72, v45 op_sel:[0,0] op_sel_hi:[1,0]
    v_pk_mul_f16 v73, v73, v45 op_sel:[0,0] op_sel_hi:[1,0]
    v_pk_lshrrev_b16 v124, s56, v44
    v_pk_lshrrev_b16 v44, s50, v44
    v_add_u32 v72, 0x40004, v72
    v_add_u32 v73, 0x40004, v73
    v_bfi_b32 v72, s49, v44, v72
    v_bfi_b32 v73, s49, v124, v73
    v_pk_mul_f16 v74, v74, v45 op_sel:[0,1] op_sel_hi:[1,1]
    v_pk_mul_f16 v75, v75, v45 op_sel:[0,1] op_sel_hi:[1,1]
    v_pk_lshrrev_b16 v124, s56, v46
    v_pk_lshrrev_b16 v46, s50, v46
    v_add_u32 v74, 0x40004, v74
    v_add_u32 v75, 0x40004, v75
    v_bfi_b32 v74, s49, v46, v74
    v_bfi_b32 v75, s49, v124, v75
b_r6l:
    v_readlane_b32 s28, v6, s58
    v_readlane_b32 s29, v7, s58
    v_mov_b32 v35, 0x80000000
    s_add_u32 s58, s58, 1
    v_mbcnt_lo_u32_b32 v34, s28, 0
    v_mbcnt_hi_u32_b32 v34, s29, v34
    s_bcnt1_i32_b64 s31, s[28:29]
    v_add_lshl_u32 v34, v34, s57, 3
    s_add_u32 s57, s57, s31
    ds_read_b64 v[32:33], v34 offset:6656
    v_readlane_b32 s28, v6, s58
    v_readlane_b32 s29, v7, s58
    v_mov_b32 v39, 0x80000000
    s_add_u32 s58, s58, 1
    v_mbcnt_lo_u32_b32 v38, s28, 0
    v_mbcnt_hi_u32_b32 v38, s29, v38
    s_bcnt1_i32_b64 s31, s[28:29]
    v_add_lshl_u32 v38, v38, s57, 3
    s_add_u32 s57, s57, s31
    ds_read_b64 v[36:37], v38 offset:6656
    v_readlane_b32 s28, v6, s58
    v_readlane_b32 s29, v7, s58
    v_mov_b32 v43, 0x80000000
    s_add_u32 s58, s58, 1
    v_mbcnt_lo_u32_b32 v42, s28, 0
    v_mbcnt_hi_u32_b32 v42, s29, v42
    s_bcnt1_i32_b64 s31, s[28:29]
    v_add_lshl_u32 v42, v42, s57, 3
    s_add_u32 s57, s57, s31
    ds_read_b64 v[40:41], v42 offset:6656
    v_mov_b32 v47, 0x80000000
    s_cmp_eq_u64 s[92:93], 0
    s_cbranch_scc1 b_nod6l
    v_readlane_b32 s28, v6, s58
    v_readlane_b32 s29, v7, s58
    s_nop 0
    s_add_u32 s58, s58, 1
    v_mbcnt_lo_u32_b32 v46, s28, 0
    v_mbcnt_hi_u32_b32 v46, s29, v46
    s_bcnt1_i32_b64 s31, s[28:29]
    v_add_lshl_u32 v46, v46, s57, 3
    s_add_u32 s57, s57, s31
    ds_read_b64 v[44:45], v46 offset:6656
b_nod6l:
    s_cmp_lt_u32 s3, 14
    s_cbranch_scc1 b_dutyBl
    s_cmp_lg_u32 s3, 15
    s_cbranch_scc1 b_dutyAl
    s_lshl_b32 s32, s94, 10
    v_add_u32 v16, s32, v5
    v_lshrrev_b32 v17, 4, v17
    v_lshrrev_b32 v124, 4, v12
    v_lshl_or_b32 v12, v124, 13, v17
    v_add_u32 v17, v17, v124
    v_lshrrev_b32 v124, 4, v13
    v_lshl_or_b32 v13, v124, 13, v17
    v_add_u32 v17, v17, v124
    v_lshrrev_b32 v124, 4, v14
    v_lshl_or_b32 v14, v124, 13, v17
    v_add_u32 v17, v17, v124
    v_lshrrev_b32 v124, 4, v15
    v_lshl_or_b32 v15, v124, 13, v17
    v_add_u32 v17, v17, v124
    ds_write_b128 v16, v[12:15] offset:2560
b_dutyAl:
    s_cmp_lg_u32 s3, 14
    s_cbranch_scc1 b_dutyBl
    s_and_b32 s31, s2, 15
    s_lshl_b32 s32, s94, 4
    s_add_u32 s31, s31, s32
    s_bfe_u32 s32, s31, 0x30003
    s_and_b32 s31, s31, 7
    s_or_b32 s31, s31, 65536
    s_or_b32 s32, s32, 393216
    v_mov_b32 v16, s31
    v_mov_b32 v17, s32
    v_add_u32 v8, v8, v120
    v_and_b32 v124, 8, v8
    v_cmpx_ne_u32 vcc, 0, v124
    ds_write_b64 v8, v[16:17] offset:48384
    s_mov_b64 exec, -1
    v_add_u32 v9, v9, v121
    v_and_b32 v124, 8, v9
    v_cmpx_ne_u32 vcc, 0, v124
    ds_write_b64 v9, v[16:17] offset:48384
    s_mov_b64 exec, -1
    v_add_u32 v10, v10, v122
    v_and_b32 v124, 8, v10
    v_cmpx_ne_u32 vcc, 0, v124
    ds_write_b64 v10, v[16:17] offset:48384
    s_mov_b64 exec, -1
    v_add_u32 v11, v11, v123
    v_and_b32 v124, 8, v11
    v_cmpx_ne_u32 vcc, 0, v124
    ds_write_b64 v11, v[16:17] offset:48384
    s_mov_b64 exec, -1
b_dutyBl:
    s_waitcnt lgkmcnt(0)
    s_mov_b64 exec, s[66:67]
    v_add_u32 v90, v90, v76
    ds_write_b64 v90, v[48:49] offset:48384
    v_add_u32 v91, v91, v77
    ds_write_b64 v91, v[50:51] offset:48384
    s_mov_b64 exec, -1
    s_mov_b64 exec, s[86:87]
    s_add_u32 s31, s59, 192
    v_add3_u32 v32, v32, v3, s31
    v_mul_hi_u32_u24 v34, 0x606061, v32
    v_mad_u32_u24 v32, v32, 12, v33
    v_mad_u32_u24 v35, v34, s51, v32
    s_mov_b64 exec, -1
    buffer_load_dwordx3 v[32:34], v35, s[8:11], 0 offen sc1
    s_mov_b64 exec, s[88:89]
    s_add_u32 s31, s59, 256
    v_add3_u32 v36, v36, v3, s31
    v_mul_hi_u32_u24 v38, 0x606061, v36
    v_mad_u32_u24 v36, v36, 12, v37
    v_mad_u32_u24 v39, v38, s51, v36
    s_mov_b64 exec, -1
    buffer_load_dwordx3 v[36:38], v39, s[8:11], 0 offen sc1
    s_mov_b64 exec, s[68:69]
    v_add_u32 v92, v92, v78
    ds_write_b64 v92, v[52:53] offset:48384
    v_add_u32 v93, v93, v79
    ds_write_b64 v93, v[54:55] offset:48384
    s_mov_b64 exec, -1
    s_mov_b64 exec, s[90:91]
    s_add_u32 s31, s59, 320
    v_add3_u32 v40, v40, v3, s31
    v_mul_hi_u32_u24 v42, 0x606061, v40
    v_mad_u32_u24 v40, v40, 12, v41
    v_mad_u32_u24 v43, v42, s51, v40
    s_mov_b64 exec, -1
    buffer_load_dwordx3 v[40:42], v43, s[8:11], 0 offen sc1
    s_mov_b64 exec, s[92:93]
    s_cbranch_execz b_nol6l
    s_add_u32 s31, s59, 384
    v_add3_u32 v44, v44, v3, s31
    v_mul_hi_u32_u24 v46, 0x606061, v44
    v_mad_u32_u24 v44, v44, 12, v45
    v_mad_u32_u24 v47, v46, s51, v44
b_nol6l:
    s_mov_b64 exec, -1
    buffer_load_dwordx3 v[44:46], v47, s[8:11], 0 offen sc1
    s_mov_b64 exec, s[70:71]
    v_add_u32 v94, v94, v80
    ds_write_b64 v94, v[56:57] offset:48384
    v_add_u32 v95, v95, v81
    ds_write_b64 v95, v[58:59] offset:48384
    s_mov_b64 exec, -1
    s_add_u32 s31, s62, 81920
    s_mov_b32 s14, s63
    buffer_store_dwordx4 v[112:115], v19, s[12:15], s31 offen sc1
    s_mov_b64 exec, s[72:73]
    v_add_u32 v96, v96, v82
    ds_write_b64 v96, v[60:61] offset:48384
    v_add_u32 v97, v97, v83
    ds_write_b64 v97, v[62:63] offset:48384
    s_mov_b64 exec, s[74:75]
    v_add_u32 v98, v98, v84
    ds_write_b64 v98, v[64:65] offset:48384
    v_add_u32 v99, v99, v85
    ds_write_b64 v99, v[66:67] offset:48384
    s_mov_b64 exec, s[76:77]
    v_add_u32 v100, v100, v86
    ds_write_b64 v100, v[68:69] offset:48384
    v_add_u32 v101, v101, v87
    ds_write_b64 v101, v[70:71] offset:48384
    s_mov_b64 exec, s[78:79]
    s_cbranch_execz b_s6l
    v_add_u32 v102, v102, v88
    ds_write_b64 v102, v[72:73] offset:48384
    v_add_u32 v103, v103, v89
    ds_write_b64 v103, v[74:75] offset:48384
b_s6l:
    s_mov_b64 exec, -1
    s_max_u32 s31, s64, s47
    s_cmp_gt_u32 s31, 57344
    s_cselect_b32 s65, -1, s65
    s_cmp_eq_u32 s45, 0
    s_cselect_b32 s61, s64, s47
    s_cselect_b32 s63, s47, s64
    s_mov_b32 s60, s30
    s_xor_b32 s62, s60, 0x2000
    s_min_u32 s61, s61, 57344
    s_and_b32 s31, s61, 0xffffe000
    s_add_u32 s61, s61, s31
    s_add_u32 s61, s61, 127
    s_and_b32 s61, s61, 0xffffff80
    s_add_u32 s61, s61, s60
    s_min_u32 s63, s63, 57344
    s_and_b32 s31, s63, 0xffffe000
    s_add_u32 s63, s63, s31
    s_add_u32 s63, s63, 127
    s_and_b32 s63, s63, 0xffffff80
    s_add_u32 s63, s63, s62
    s_add_u32 s30, s30, 33554432
    s_add_u32 s94, s94, 1
    s_waitcnt lgkmcnt(0)
    s_barrier
    s_cmp_lt_u32 s94, 3
    s_cbranch_scc1 b_loop
b_last:
    s_mov_b64 s[66:67], s[80:81]
    s_mov_b64 s[68:69], s[82:83]
    s_mov_b64 s[70:71], s[84:85]
    s_mov_b64 s[72:73], s[86:87]
    s_mov_b64 s[74:75], s[88:89]
    s_mov_b64 s[76:77], s[90:91]
    s_mov_b64 s[78:79], s[92:93]
    s_lshr_b32 s31, s35, 2
    s_lshl_b32 s31, s31, 12
    s_and_b32 s32, s35, 3
    s_lshl_b32 s32, s32, 2
    s_add_u32 s31, s31, s32
    s_lshl_b32 s32, s3, 8
    s_add_u32 s31, s31, s32
    s_add_u32 s38, s31, 234881024
    s_mov_b32 s39, 4
    v_and_b32 v17, 48, v3
    v_lshl_or_b32 v16, v17, 26, v5
    s_lshl_b32 s31, s39, 18
    s_add_u32 s31, s31, s38
    buffer_load_dword v16, v16, s[8:11], s31 offen sc1
    ds_read_b128 v[104:107], v2 offset:0
    ds_read_b128 v[108:111], v1 offset:8192
    ds_read_b128 v[112:115], v2 offset:49152
    ds_read_b128 v[116:119], v2 offset:16384
    s_waitcnt vmcnt(11)
    v_alignbit_b32 v124, v20, v20, 19
    v_and_b32 v124, 0x7ff8, v124
    ds_read_b64 v[48:49], v124 offset:23296
    v_alignbit_b32 v125, v22, v22, 19
    v_and_b32 v125, 0x7ff8, v125
    ds_read_b64 v[50:51], v125 offset:23296
    s_waitcnt vmcnt(10)
    v_alignbit_b32 v124, v24, v24, 19
    v_and_b32 v124, 0x7ff8, v124
    ds_read_b64 v[52:53], v124 offset:23296
    v_alignbit_b32 v125, v26, v26, 19
    v_and_b32 v125, 0x7ff8, v125
    ds_read_b64 v[54:55], v125 offset:23296
    s_waitcnt vmcnt(9)
    v_alignbit_b32 v124, v28, v28, 19
    v_and_b32 v124, 0x7ff8, v124
    ds_read_b64 v[56:57], v124 offset:23296
    v_alignbit_b32 v125, v30, v30, 19
    v_and_b32 v125, 0x7ff8, v125
    ds_read_b64 v[58:59], v125 offset:23296
    s_waitcnt lgkmcnt(0)
    s_mov_b64 exec, s[66:67]
    v_lshlrev_b32_sdwa v76, 2, v20 dst_sel:DWORD dst_unused:UNUSED_PAD src0_sel:DWORD src1_sel:BYTE_1
    ds_add_rtn_u32 v90, v76, v4 offset:512
    v_lshlrev_b32_sdwa v77, 2, v22 dst_sel:DWORD dst_unused:UNUSED_PAD src0_sel:DWORD src1_sel:BYTE_1
    ds_add_rtn_u32 v91, v77, v4 offset:512
    s_mov_b64 exec, s[68:69]
    v_lshlrev_b32_sdwa v78, 2, v24 dst_sel:DWORD dst_unused:UNUSED_PAD src0_sel:DWORD src1_sel:BYTE_1
    ds_add_rtn_u32 v92, v78, v4 offset:512
    v_lshlrev_b32_sdwa v79, 2, v26 dst_sel:DWORD dst_unused:UNUSED_PAD src0_sel:DWORD src1_sel:BYTE_1
    ds_add_rtn_u32 v93, v79, v4 offset:512
    s_mov_b64 exec, s[70:71]
    v_lshlrev_b32_sdwa v80, 2, v28 dst_sel:DWORD dst_unused:UNUSED_PAD src0_sel:DWORD src1_sel:BYTE_1
    ds_add_rtn_u32 v94, v80, v4 offset:512
    v_lshlrev_b32_sdwa v81, 2, v30 dst_sel:DWORD dst_unused:UNUSED_PAD src0_sel:DWORD src1_sel:BYTE_1
    ds_add_rtn_u32 v95, v81, v4 offset:512
    s_mov_b64 exec, -1
    s_add_u32 s31, s60, 0
    s_mov_b32 s14, s61
    buffer_store_dwordx4 v[104:107], v19, s[12:15], s31 offen sc1
    s_add_u32 s31, s62, 16384
    s_mov_b32 s14, s63
    buffer_store_dwordx4 v[108:111], v19, s[12:15], s31 offen sc1
    v_pk_mul_f16 v48, v48, v21 op_sel:[0,0] op_sel_hi:[1,0]
    v_pk_mul_f16 v49, v49, v21 op_sel:[0,0] op_sel_hi:[1,0]
    v_pk_lshrrev_b16 v124, s56, v20
    v_pk_lshrrev_b16 v20, s50, v20
    v_add_u32 v48, 0x40004, v48
    v_add_u32 v49, 0x40004, v49
    v_bfi_b32 v48, s49, v20, v48
    v_bfi_b32 v49, s49, v124, v49
    v_pk_mul_f16 v50, v50, v21 op_sel:[0,1] op_sel_hi:[1,1]
    v_pk_mul_f16 v51, v51, v21 op_sel:[0,1] op_sel_hi:[1,1]
    v_pk_lshrrev_b16 v124, s56, v22
    v_pk_lshrrev_b16 v22, s50, v22
    v_add_u32 v50, 0x40004, v50
    v_add_u32 v51, 0x40004, v51
    v_bfi_b32 v50, s49, v22, v50
    v_bfi_b32 v51, s49, v124, v51
    s_waitcnt vmcnt(7)
    s_mov_b64 exec, s[72:73]
    v_lshlrev_b32_sdwa v82, 2, v32 dst_sel:DWORD dst_unused:UNUSED_PAD src0_sel:DWORD src1_sel:BYTE_1
    ds_add_rtn_u32 v96, v82, v4 offset:512
    v_lshlrev_b32_sdwa v83, 2, v34 dst_sel:DWORD dst_unused:UNUSED_PAD src0_sel:DWORD src1_sel:BYTE_1
    ds_add_rtn_u32 v97, v83, v4 offset:512
    s_mov_b64 exec, -1
    v_pk_mul_f16 v52, v52, v25 op_sel:[0,0] op_sel_hi:[1,0]
    v_pk_mul_f16 v53, v53, v25 op_sel:[0,0] op_sel_hi:[1,0]
    v_pk_lshrrev_b16 v124, s56, v24
    v_pk_lshrrev_b16 v24, s50, v24
    v_add_u32 v52, 0x40004, v52
    v_add_u32 v53, 0x40004, v53
    v_bfi_b32 v52, s49, v24, v52
    v_bfi_b32 v53, s49, v124, v53
    v_pk_mul_f16 v54, v54, v25 op_sel:[0,1] op_sel_hi:[1,1]
    v_pk_mul_f16 v55, v55, v25 op_sel:[0,1] op_sel_hi:[1,1]
    v_pk_lshrrev_b16 v124, s56, v26
    v_pk_lshrrev_b16 v26, s50, v26
    v_add_u32 v54, 0x40004, v54
    v_add_u32 v55, 0x40004, v55
    v_bfi_b32 v54, s49, v26, v54
    v_bfi_b32 v55, s49, v124, v55
    s_waitcnt vmcnt(6)
    s_mov_b64 exec, s[74:75]
    v_lshlrev_b32_sdwa v84, 2, v36 dst_sel:DWORD dst_unused:UNUSED_PAD src0_sel:DWORD src1_sel:BYTE_1
    ds_add_rtn_u32 v98, v84, v4 offset:512
    v_lshlrev_b32_sdwa v85, 2, v38 dst_sel:DWORD dst_unused:UNUSED_PAD src0_sel:DWORD src1_sel:BYTE_1
    ds_add_rtn_u32 v99, v85, v4 offset:512
    s_mov_b64 exec, -1
    s_add_u32 s31, s60, 98304
    s_mov_b32 s14, s61
    buffer_store_dwordx4 v[112:115], v19, s[12:15], s31 offen sc1
    v_pk_mul_f16 v56, v56, v29 op_sel:[0,0] op_sel_hi:[1,0]
    v_pk_mul_f16 v57, v57, v29 op_sel:[0,0] op_sel_hi:[1,0]
    v_pk_lshrrev_b16 v124, s56, v28
    v_pk_lshrrev_b16 v28, s50, v28
    v_add_u32 v56, 0x40004, v56
    v_add_u32 v57, 0x40004, v57
    v_bfi_b32 v56, s49, v28, v56
    v_bfi_b32 v57, s49, v124, v57
    v_pk_mul_f16 v58, v58, v29 op_sel:[0,1] op_sel_hi:[1,1]
    v_pk_mul_f16 v59, v59, v29 op_sel:[0,1] op_sel_hi:[1,1]
    v_pk_lshrrev_b16 v124, s56, v30
    v_pk_lshrrev_b16 v30, s50, v30
    v_add_u32 v58, 0x40004, v58
    v_add_u32 v59, 0x40004, v59
    v_bfi_b32 v58, s49, v30, v58
    v_bfi_b32 v59, s49, v124, v59
    s_mul_i32 s57, s3, 132
    s_mov_b32 s43, s57
    s_mov_b32 s53, 0
    s_mov_b32 s36, 0
    s_mov_b32 s58, 0
    s_mov_b32 s59, 0
    s_mov_b32 s82, 0xffff
    s_mov_b32 s83, 0
    s_mov_b32 s84, 320
    s_lshr_b32 s55, s35, 7
    s_xor_b32 s55, s55, s3
    s_and_b32 s55, s55, 1
    s_lshl_b32 s55, s55, 13
    v_bfrev_b32 v8, 2
    v_bfrev_b32 v9, 2
    v_mov_b32 v12, 0
    v_mov_b32 v13, 0
    s_lshl_b32 s31, s57, 2
    v_lshl_add_u32 v14, v3, 3, s48
    v_lshl_add_u32 v15, v3, 3, s31
    ds_write_b64 v14, v[12:13] offset:15104
    ds_write_b64 v15, v[8:9] offset:6656
    s_lshl_b32 s33, s39, 4
    s_add_u32 s33, s33, s3
    s_sub_u32 s33, s33, 16
    s_lshl_b32 s33, s33, 20
    v_mul_u32_u24 v10, 57344, v3
    v_add_u32 v10, s33, v10
    s_waitcnt vmcnt(3)
    s_mov_b32 s33, 131072
f_pollc4:
    v_cmp_gt_i32 vcc, 0, v16
    s_cmp_eq_u64 vcc, s[82:83]
    s_cbranch_scc1 f_polledc4
    s_sub_u32 s33, s33, 1
    s_cbranch_scc1 f_done
    s_cmp_ge_u32 s33, 131071
    s_cbranch_scc1 f_noslc4
    s_sleep 32
f_noslc4:
    v_and_b32 v17, 48, v3
    v_lshl_or_b32 v16, v17, 26, v5
    s_lshl_b32 s31, s39, 18
    s_add_u32 s31, s31, s38
    buffer_load_dword v16, v16, s[8:11], s31 offen sc1
    s_waitcnt vmcnt(0)
    s_branch f_pollc4
f_polledc4:
    v_bfe_u32 v12, v16, 13, 13
    v_and_b32 v16, 0x1fff, v16
    v_cmp_lt_u32 vcc, 0, v12
    v_mov_b32 v13, v12
    v_lshl_add_u32 v6, v3, 3, s48
    v_mbcnt_lo_u32_b32 v14, vcc_lo, 0
    s_nop 1
    v_add_u32_dpp v13, v13, v13 row_shr:1 row_mask:0xf bank_mask:0xf
    s_nop 1
    v_add_u32_dpp v13, v13, v13 row_shr:2 row_mask:0xf bank_mask:0xf
    s_nop 1
    v_add_u32_dpp v13, v13, v13 row_shr:4 row_mask:0xf bank_mask:0xf
    s_nop 1
    v_add_u32_dpp v13, v13, v13 row_shr:8 row_mask:0xf bank_mask:0xf
    v_add_lshl_u32 v14, v14, s43, 2
    v_readlane_b32 s33, v13, 15
    v_sub_u32 v13, v13, v12
    v_add_u32 v13, s53, v13
    s_bcnt1_i32_b64 s31, vcc
    s_add_u32 s43, s43, s31
    s_add_u32 s39, s39, 1
    s_add_u32 s53, s53, s33
    s_add_u32 s36, s36, s33
    s_cmp_lt_u32 s53, s84
    s_cselect_b32 s31, -1, s53
    s_cmp_gt_u32 s31, 3072
    s_cselect_b64 s[80:81], -1, 0
    s_cselect_b32 s36, 0, s36
    s_cbranch_scc1 c_nomap4
    v_sub_u32 v16, v16, v13
    v_lshl_add_u32 v10, v16, 4, v10
    v_cmpx_lt_u32 vcc, 0, v12
    ds_write_b32 v14, v10 offset:6656
    v_add3_u32 v8, v13, v12, -1
    v_lshrrev_b32 v9, 3, v8
    v_and_b32 v9, -4, v9
    v_lshlrev_b32 v8, v8, 1
    v_add_u32 v9, s48, v9
    ds_or_b32 v9, v8 offset:15104
    s_mov_b64 exec, -1
c_nomap4:
    ds_read_b64 v[6:7], v6 offset:15104
    s_waitcnt lgkmcnt(0)
    v_readlane_b32 s28, v6, s58
    v_readlane_b32 s29, v7, s58
    s_add_u32 s58, s58, 1
    s_nop 0
    v_mbcnt_lo_u32_b32 v22, s28, 0
    v_mbcnt_hi_u32_b32 v22, s29, v22
    s_bcnt1_i32_b64 s31, s[28:29]
    v_add_lshl_u32 v22, v22, s57, 2
    s_add_u32 s57, s57, s31
    ds_read_b32 v20, v22 offset:6656
    v_readlane_b32 s28, v6, s58
    v_readlane_b32 s29, v7, s58
    s_add_u32 s58, s58, 1
    s_nop 0
    v_mbcnt_lo_u32_b32 v26, s28, 0
    v_mbcnt_hi_u32_b32 v26, s29, v26
    s_bcnt1_i32_b64 s31, s[28:29]
    v_add_lshl_u32 v26, v26, s57, 2
    s_add_u32 s57, s57, s31
    ds_read_b32 v24, v26 offset:6656
    v_readlane_b32 s28, v6, s58
    v_readlane_b32 s29, v7, s58
    s_add_u32 s58, s58, 1
    s_nop 0
    v_mbcnt_lo_u32_b32 v30, s28, 0
    v_mbcnt_hi_u32_b32 v30, s29, v30
    s_bcnt1_i32_b64 s31, s[28:29]
    v_add_lshl_u32 v30, v30, s57, 2
    s_add_u32 s57, s57, s31
    ds_read_b32 v28, v30 offset:6656
    ds_read_b128 v[104:107], v1 offset:24576
    ds_read_b128 v[108:111], v2 offset:32768
    ds_read_b128 v[112:115], v1 offset:40960
    s_mov_b64 exec, s[76:77]
    v_lshlrev_b32_sdwa v86, 2, v40 dst_sel:DWORD dst_unused:UNUSED_PAD src0_sel:DWORD src1_sel:BYTE_1
    ds_add_rtn_u32 v100, v86, v4 offset:512
    v_lshlrev_b32_sdwa v87, 2, v42 dst_sel:DWORD dst_unused:UNUSED_PAD src0_sel:DWORD src1_sel:BYTE_1
    ds_add_rtn_u32 v101, v87, v4 offset:512
    s_mov_b64 exec, s[78:79]
    s_cbranch_execz b_k6z
    v_lshlrev_b32_sdwa v88, 2, v44 dst_sel:DWORD dst_unused:UNUSED_PAD src0_sel:DWORD src1_sel:BYTE_1
    ds_add_rtn_u32 v102, v88, v4 offset:512
    v_lshlrev_b32_sdwa v89, 2, v46 dst_sel:DWORD dst_unused:UNUSED_PAD src0_sel:DWORD src1_sel:BYTE_1
    ds_add_rtn_u32 v103, v89, v4 offset:512
b_k6z:
    s_waitcnt lgkmcnt(0)
    s_mov_b64 exec, -1
    v_add3_u32 v20, v20, v5, s59
    v_and_b32 v22, 0xffffe000, v20
    v_add_u32 v22, v20, v22
    s_add_u32 s59, s59, 0x400
    buffer_load_dwordx4 v[20:23], v22, s[8:11], s55 offen sc1
    v_add3_u32 v24, v24, v5, s59
    v_and_b32 v26, 0xffffe000, v24
    v_add_u32 v26, v24, v26
    s_add_u32 s59, s59, 0x400
    buffer_load_dwordx4 v[24:27], v26, s[8:11], s55 offen sc1
    v_add3_u32 v28, v28, v5, s59
    v_and_b32 v30, 0xffffe000, v28
    v_add_u32 v30, v28, v30
    s_add_u32 s59, s59, 0x400
    buffer_load_dwordx4 v[28:31], v30, s[8:11], s55 offen sc1
    s_waitcnt vmcnt(7)
    s_barrier
    s_cmp_lg_u32 s3, 2
    s_cbranch_scc1 b_norowz
    s_add_u32 s47, s94, 2
    s_and_b32 s31, s47, 3
    s_lshl_b32 s31, s31, 10
    v_add_u32 v8, s31, v5
    v_mov_b32 v12, 0
    ds_read_b128 v[8:11], v8 offset:2560
    ds_read_b32 v12, v12 offset:308
    s_lshl_b32 s31, s47, 18
    s_lshl_b32 s33, s2, 4
    s_add_u32 s31, s31, s33
    s_add_u32 s31, s31, 234881024
    s_or_b32 s32, s65, 0x80000000
    s_waitcnt lgkmcnt(0)
    v_or3_b32 v8, v8, s32, v12
    v_or3_b32 v9, v9, s32, v12
    v_or3_b32 v10, v10, s32, v12
    v_or3_b32 v11, v11, s32, v12
    v_lshlrev_b32 v12, 8, v5
    buffer_store_dwordx4 v[8:11], v12, s[8:11], s31 offen sc1
    s_nop 1
b_norowz:
    ds_read_b128 v[8:11], v5 offset:512
    v_alignbit_b32 v124, v32, v32, 19
    v_and_b32 v124, 0x7ff8, v124
    ds_read_b64 v[60:61], v124 offset:23296
    v_alignbit_b32 v125, v34, v34, 19
    v_and_b32 v125, 0x7ff8, v125
    ds_read_b64 v[62:63], v125 offset:23296
    v_alignbit_b32 v124, v36, v36, 19
    v_and_b32 v124, 0x7ff8, v124
    ds_read_b64 v[64:65], v124 offset:23296
    v_alignbit_b32 v125, v38, v38, 19
    v_and_b32 v125, 0x7ff8, v125
    ds_read_b64 v[66:67], v125 offset:23296
    v_alignbit_b32 v124, v40, v40, 19
    v_and_b32 v124, 0x7ff8, v124
    ds_read_b64 v[68:69], v124 offset:23296
    v_alignbit_b32 v125, v42, v42, 19
    v_and_b32 v125, 0x7ff8, v125
    ds_read_b64 v[70:71], v125 offset:23296
    s_cmp_eq_u64 s[78:79], 0
    s_cbranch_scc1 b_g6z
    v_alignbit_b32 v124, v44, v44, 19
    v_and_b32 v124, 0x7ff8, v124
    ds_read_b64 v[72:73], v124 offset:23296
    v_alignbit_b32 v125, v46, v46, 19
    v_and_b32 v125, 0x7ff8, v125
    ds_read_b64 v[74:75], v125 offset:23296
b_g6z:
    s_waitcnt lgkmcnt(6)
    s_add_u32 s31, s60, 32768
    s_mov_b32 s14, s61
    buffer_store_dwordx4 v[116:119], v19, s[12:15], s31 offen sc1
    v_sub_u32 v12, v8, v120
    v_add_u32 v12, 8, v12
    v_sub_u32 v13, v9, v121
    v_add_u32 v13, 8, v13
    v_sub_u32 v14, v10, v122
    v_add_u32 v14, 8, v14
    v_sub_u32 v15, v11, v123
    v_add_u32 v15, 8, v15
    v_and_b32 v12, -16, v12
    v_and_b32 v13, -16, v13
    v_and_b32 v14, -16, v14
    v_and_b32 v15, -16, v15
    v_add_u32 v17, v12, v13
    v_add3_u32 v17, v17, v14, v15
    v_mov_b32 v16, v17
    s_nop 1
    v_add_u32_dpp v16, v16, v16 row_shr:1 row_mask:0xf bank_mask:0xf
    s_nop 1
    v_add_u32_dpp v16, v16, v16 row_shr:2 row_mask:0xf bank_mask:0xf
    s_nop 1
    v_add_u32_dpp v16, v16, v16 row_shr:4 row_mask:0xf bank_mask:0xf
    s_nop 1
    v_add_u32_dpp v16, v16, v16 row_shr:8 row_mask:0xf bank_mask:0xf
    s_nop 1
    v_add_u32_dpp v16, v16, v16 row_bcast:15 row_mask:0xa bank_mask:0xf
    v_sub_u32 v17, v16, v17
    v_readlane_b32 s64, v16, 31
    v_readlane_b32 s47, v16, 63
    v_add_u32 v16, v17, v18
    v_sub_u32 v120, v16, v120
    v_swap_b32 v120, v8
    v_add_u32 v16, v16, v12
    v_sub_u32 v121, v16, v121
    v_swap_b32 v121, v9
    v_add_u32 v16, v16, v13
    v_sub_u32 v122, v16, v122
    v_swap_b32 v122, v10
    v_add_u32 v16, v16, v14
    v_sub_u32 v123, v16, v123
    v_swap_b32 v123, v11
    s_waitcnt lgkmcnt(0)
    ds_write_b128 v5, v[8:11] offset:1536
    s_mov_b64 exec, s[66:67]
    ds_read_b32 v76, v76 offset:1536
    ds_read_b32 v77, v77 offset:1536
    s_mov_b64 exec, s[68:69]
    ds_read_b32 v78, v78 offset:1536
    ds_read_b32 v79, v79 offset:1536
    s_mov_b64 exec, s[70:71]
    ds_read_b32 v80, v80 offset:1536
    ds_read_b32 v81, v81 offset:1536
    s_mov_b64 exec, s[72:73]
    ds_read_b32 v82, v82 offset:1536
    ds_read_b32 v83, v83 offset:1536
    s_mov_b64 exec, s[74:75]
    ds_read_b32 v84, v84 offset:1536
    ds_read_b32 v85, v85 offset:1536
    s_mov_b64 exec, s[76:77]
    ds_read_b32 v86, v86 offset:1536
    ds_read_b32 v87, v87 offset:1536
    s_mov_b64 exec, s[78:79]
    s_cbranch_execz b_b6z
    ds_read_b32 v88, v88 offset:1536
    ds_read_b32 v89, v89 offset:1536
b_b6z:
    s_mov_b64 exec, -1
    s_add_u32 s31, s62, 49152
    s_mov_b32 s14, s63
    buffer_store_dwordx4 v[104:107], v19, s[12:15], s31 offen sc1
    v_pk_mul_f16 v60, v60, v33 op_sel:[0,0] op_sel_hi:[1,0]
    v_pk_mul_f16 v61, v61, v33 op_sel:[0,0] op_sel_hi:[1,0]
    v_pk_lshrrev_b16 v124, s56, v32
    v_pk_lshrrev_b16 v32, s50, v32
    v_add_u32 v60, 0x40004, v60
    v_add_u32 v61, 0x40004, v61
    v_bfi_b32 v60, s49, v32, v60
    v_bfi_b32 v61, s49, v124, v61
    v_pk_mul_f16 v62, v62, v33 op_sel:[0,1] op_sel_hi:[1,1]
    v_pk_mul_f16 v63, v63, v33 op_sel:[0,1] op_sel_hi:[1,1]
    v_pk_lshrrev_b16 v124, s56, v34
    v_pk_lshrrev_b16 v34, s50, v34
    v_add_u32 v62, 0x40004, v62
    v_add_u32 v63, 0x40004, v63
    v_bfi_b32 v62, s49, v34, v62
    v_bfi_b32 v63, s49, v124, v63
    v_pk_mul_f16 v64, v64, v37 op_sel:[0,0] op_sel_hi:[1,0]
    v_pk_mul_f16 v65, v65, v37 op_sel:[0,0] op_sel_hi:[1,0]
    v_pk_lshrrev_b16 v124, s56, v36
    v_pk_lshrrev_b16 v36, s50, v36
    v_add_u32 v64, 0x40004, v64
    v_add_u32 v65, 0x40004, v65
    v_bfi_b32 v64, s49, v36, v64
    v_bfi_b32 v65, s49, v124, v65
    v_pk_mul_f16 v66, v66, v37 op_sel:[0,1] op_sel_hi:[1,1]
    v_pk_mul_f16 v67, v67, v37 op_sel:[0,1] op_sel_hi:[1,1]
    v_pk_lshrrev_b16 v124, s56, v38
    v_pk_lshrrev_b16 v38, s50, v38
    v_add_u32 v66, 0x40004, v66
    v_add_u32 v67, 0x40004, v67
    v_bfi_b32 v66, s49, v38, v66
    v_bfi_b32 v67, s49, v124, v67
    s_add_u32 s31, s60, 65536
    s_mov_b32 s14, s61
    buffer_store_dwordx4 v[108:111], v19, s[12:15], s31 offen sc1
    v_pk_mul_f16 v68, v68, v41 op_sel:[0,0] op_sel_hi:[1,0]
    v_pk_mul_f16 v69, v69, v41 op_sel:[0,0] op_sel_hi:[1,0]
    v_pk_lshrrev_b16 v124, s56, v40
    v_pk_lshrrev_b16 v40, s50, v40
    v_add_u32 v68, 0x40004, v68
    v_add_u32 v69, 0x40004, v69
    v_bfi_b32 v68, s49, v40, v68
    v_bfi_b32 v69, s49, v124, v69
    v_pk_mul_f16 v70, v70, v41 op_sel:[0,1] op_sel_hi:[1,1]
    v_pk_mul_f16 v71, v71, v41 op_sel:[0,1] op_sel_hi:[1,1]
    v_pk_lshrrev_b16 v124, s56, v42
    v_pk_lshrrev_b16 v42, s50, v42
    v_add_u32 v70, 0x40004, v70
    v_add_u32 v71, 0x40004, v71
    v_bfi_b32 v70, s49, v42, v70
    v_bfi_b32 v71, s49, v124, v71
    s_cmp_eq_u64 s[78:79], 0
    s_cbranch_scc1 b_r6z
    v_pk_mul_f16 v72, v72, v45 op_sel:[0,0] op_sel_hi:[1,0]
    v_pk_mul_f16 v73, v73, v45 op_sel:[0,0] op_sel_hi:[1,0]
    v_pk_lshrrev_b16 v124, s56, v44
    v_pk_lshrrev_b16 v44, s50, v44
    v_add_u32 v72, 0x40004, v72
    v_add_u32 v73, 0x40004, v73
    v_bfi_b32 v72, s49, v44, v72
    v_bfi_b32 v73, s49, v124, v73
    v_pk_mul_f16 v74, v74, v45 op_sel:[0,1] op_sel_hi:[1,1]
    v_pk_mul_f16 v75, v75, v45 op_sel:[0,1] op_sel_hi:[1,1]
    v_pk_lshrrev_b16 v124, s56, v46
    v_pk_lshrrev_b16 v46, s50, v46
    v_add_u32 v74, 0x40004, v74
    v_add_u32 v75, 0x40004, v75
    v_bfi_b32 v74, s49, v46, v74
    v_bfi_b32 v75, s49, v124, v75
b_r6z:
    v_readlane_b32 s28, v6, s58
    v_readlane_b32 s29, v7, s58
    s_add_u32 s58, s58, 1
    s_nop 0
    v_mbcnt_lo_u32_b32 v34, s28, 0
    v_mbcnt_hi_u32_b32 v34, s29, v34
    s_bcnt1_i32_b64 s31, s[28:29]
    v_add_lshl_u32 v34, v34, s57, 2
    s_add_u32 s57, s57, s31
    ds_read_b32 v32, v34 offset:6656
    v_readlane_b32 s28, v6, s58
    v_readlane_b32 s29, v7, s58
    s_add_u32 s58, s58, 1
    s_nop 0
    v_mbcnt_lo_u32_b32 v38, s28, 0
    v_mbcnt_hi_u32_b32 v38, s29, v38
    s_bcnt1_i32_b64 s31, s[28:29]
    v_add_lshl_u32 v38, v38, s57, 2
    s_add_u32 s57, s57, s31
    ds_read_b32 v36, v38 offset:6656
    s_cmp_lt_u32 s3, 14
    s_cbranch_scc1 b_dutyBz
    s_cmp_lg_u32 s3, 15
    s_cbranch_scc1 b_dutyAz
    s_lshl_b32 s32, s94, 10
    v_add_u32 v16, s32, v5
    v_lshrrev_b32 v17, 4, v17
    v_lshrrev_b32 v124, 4, v12
    v_lshl_or_b32 v12, v124, 13, v17
    v_add_u32 v17, v17, v124
    v_lshrrev_b32 v124, 4, v13
    v_lshl_or_b32 v13, v124, 13, v17
    v_add_u32 v17, v17, v124
    v_lshrrev_b32 v124, 4, v14
    v_lshl_or_b32 v14, v124, 13, v17
    v_add_u32 v17, v17, v124
    v_lshrrev_b32 v124, 4, v15
    v_lshl_or_b32 v15, v124, 13, v17
    v_add_u32 v17, v17, v124
    ds_write_b128 v16, v[12:15] offset:2560
b_dutyAz:
    s_cmp_lg_u32 s3, 14
    s_cbranch_scc1 b_dutyBz
    s_and_b32 s31, s2, 15
    s_lshl_b32 s32, s94, 4
    s_add_u32 s31, s31, s32
    s_bfe_u32 s32, s31, 0x30003
    s_and_b32 s31, s31, 7
    s_or_b32 s31, s31, 65536
    s_or_b32 s32, s32, 393216
    v_mov_b32 v16, s31
    v_mov_b32 v17, s32
    v_add_u32 v8, v8, v120
    v_and_b32 v124, 8, v8
    v_cmpx_ne_u32 vcc, 0, v124
    ds_write_b64 v8, v[16:17] offset:48384
    s_mov_b64 exec, -1
    v_add_u32 v9, v9, v121
    v_and_b32 v124, 8, v9
    v_cmpx_ne_u32 vcc, 0, v124
    ds_write_b64 v9, v[16:17] offset:48384
    s_mov_b64 exec, -1
    v_add_u32 v10, v10, v122
    v_and_b32 v124, 8, v10
    v_cmpx_ne_u32 vcc, 0, v124
    ds_write_b64 v10, v[16:17] offset:48384
    s_mov_b64 exec, -1
    v_add_u32 v11, v11, v123
    v_and_b32 v124, 8, v11
    v_cmpx_ne_u32 vcc, 0, v124
    ds_write_b64 v11, v[16:17] offset:48384
    s_mov_b64 exec, -1
b_dutyBz:
    s_waitcnt lgkmcnt(0)
    s_mov_b64 exec, s[66:67]
    v_add_u32 v90, v90, v76
    ds_write_b64 v90, v[48:49] offset:48384
    v_add_u32 v91, v91, v77
    ds_write_b64 v91, v[50:51] offset:48384
    s_mov_b64 exec, -1
    v_add3_u32 v32, v32, v5, s59
    v_and_b32 v34, 0xffffe000, v32
    v_add_u32 v34, v32, v34
    s_add_u32 s59, s59, 0x400
    buffer_load_dwordx4 v[32:35], v34, s[8:11], s55 offen sc1
    v_add3_u32 v36, v36, v5, s59
    v_and_b32 v38, 0xffffe000, v36
    v_add_u32 v38, v36, v38
    s_add_u32 s59, s59, 0x400
    buffer_load_dwordx4 v[36:39], v38, s[8:11], s55 offen sc1
    s_mov_b64 exec, s[68:69]
    v_add_u32 v92, v92, v78
    ds_write_b64 v92, v[52:53] offset:48384
    v_add_u32 v93, v93, v79
    ds_write_b64 v93, v[54:55] offset:48384
    s_mov_b64 exec, -1
    s_mov_b64 exec, s[70:71]
    v_add_u32 v94, v94, v80
    ds_write_b64 v94, v[56:57] offset:48384
    v_add_u32 v95, v95, v81
    ds_write_b64 v95, v[58:59] offset:48384
    s_mov_b64 exec, -1
    s_add_u32 s31, s62, 81920
    s_mov_b32 s14, s63
    buffer_store_dwordx4 v[112:115], v19, s[12:15], s31 offen sc1
    s_mov_b64 exec, s[72:73]
    v_add_u32 v96, v96, v82
    ds_write_b64 v96, v[60:61] offset:48384
    v_add_u32 v97, v97, v83
    ds_write_b64 v97, v[62:63] offset:48384
    s_mov_b64 exec, s[74:75]
    v_add_u32 v98, v98, v84
    ds_write_b64 v98, v[64:65] offset:48384
    v_add_u32 v99, v99, v85
    ds_write_b64 v99, v[66:67] offset:48384
    s_mov_b64 exec, s[76:77]
    v_add_u32 v100, v100, v86
    ds_write_b64 v100, v[68:69] offset:48384
    v_add_u32 v101, v101, v87
    ds_write_b64 v101, v[70:71] offset:48384
    s_mov_b64 exec, s[78:79]
    s_cbranch_execz b_s6z
    v_add_u32 v102, v102, v88
    ds_write_b64 v102, v[72:73] offset:48384
    v_add_u32 v103, v103, v89
    ds_write_b64 v103, v[74:75] offset:48384
b_s6z:
    s_mov_b64 exec, -1
    s_max_u32 s31, s64, s47
    s_cmp_gt_u32 s31, 57344
    s_cselect_b32 s65, -1, s65
    s_cmp_eq_u32 s45, 0
    s_cselect_b32 s61, s64, s47
    s_cselect_b32 s63, s47, s64
    s_mov_b32 s60, s30
    s_xor_b32 s62, s60, 0x2000
    s_min_u32 s61, s61, 57344
    s_and_b32 s31, s61, 0xffffe000
    s_add_u32 s61, s61, s31
    s_add_u32 s61, s61, 127
    s_and_b32 s61, s61, 0xffffff80
    s_add_u32 s61, s61, s60
    s_min_u32 s63, s63, 57344
    s_and_b32 s31, s63, 0xffffe000
    s_add_u32 s63, s63, s31
    s_add_u32 s63, s63, 127
    s_and_b32 s63, s63, 0xffffff80
    s_add_u32 s63, s63, s62
    s_add_u32 s30, s30, 33554432
    s_load_dwordx2 s[16:17], s[0:1], 0
    s_load_dwordx2 s[20:21], s[0:1], 24
    s_load_dwordx2 s[24:25], s[0:1], 88
    s_mov_b32 s18, 6400000
    s_mov_b32 s22, 1600000
    s_mov_b32 s26, 6400000
    v_mov_b32 v4, 0x00070007
    v_mov_b32 v8, 48384
    v_mov_b32 v9, 0xffffe000
    v_lshrrev_b32 v10, 1, v5
    s_mov_b32 s87, 67108880
    s_mov_b32 s85, 536871040
    s_lshl_b32 s40, s3, 17
    s_lshl_b32 s32, s35, 9
    s_add_u32 s40, s40, s32
    v_and_b32 v76, 3, v0
    v_lshlrev_b32 v77, 6, v76
    ds_read_b128 v[112:115], v77 offset:0
    ds_read_b128 v[116:119], v77 offset:16
    ds_read_b64 v[120:121], v77 offset:32
    v_lshlrev_b32 v17, 2, v76
    v_lshlrev_b32 v77, 3, v76
    v_mov_b32 v78, 2156433536
    v_bfe_u32 v78, v78, v77, 8
    v_lshlrev_b32 v76, 4, v76
    v_add_u32 v40, -127, v78
    v_lshlrev_b32 v40, 10, v40
    v_mov_b32 v41, 0
    v_lshlrev_b64 v[40:41], v76, v[40:41]
    v_lshl_or_b32 v122, v78, 1, 1
    v_lshlrev_b32 v122, 22, v122
    v_mov_b32 v123, v122
    v_mov_b32 v124, v122
    v_mov_b32 v125, v122
    v_lshlrev_b32 v79, 2, v3
    ds_read_b32 v79, v79 offset:256
    s_waitcnt lgkmcnt(0)
    v_readlane_b32 s66, v79, 0
    v_readlane_b32 s67, v79, 1
    v_readlane_b32 s68, v79, 2
    v_readlane_b32 s69, v79, 3
    v_readlane_b32 s70, v79, 4
    v_readlane_b32 s71, v79, 5
    v_readlane_b32 s72, v79, 6
    v_readlane_b32 s73, v79, 7
    v_lshrrev_b32 v90, 3, v5
    s_lshr_b32 s31, s40, 2
    buffer_load_ushort v92, v90, s[20:23], s31 offen
    s_add_u32 s31, s31, 524288
    buffer_load_ushort v93, v90, s[20:23], s31 offen
    s_add_u32 s31, s31, 524288
    buffer_load_ushort v94, v90, s[20:23], s31 offen
    s_add_u32 s31, s31, 524288
    buffer_load_ushort v95, v90, s[20:23], s31 offen
    s_mov_b32 s31, s40
    buffer_load_dwordx2 v[98:99], v10, s[16:19], s31 offen
    s_add_u32 s31, s31, 2097152
    buffer_load_dwordx2 v[102:103], v10, s[16:19], s31 offen
    s_add_u32 s31, s31, 2097152
    buffer_load_dwordx2 v[106:107], v10, s[16:19], s31 offen
    s_add_u32 s31, s31, 2097152
    buffer_load_dwordx2 v[110:111], v10, s[16:19], s31 offen
    v_mov_b32 v80, 0
    v_mov_b32 v81, 0
    v_mov_b32 v82, 0
    v_mov_b32 v83, 0
    s_waitcnt vmcnt(8)
    s_waitcnt lgkmcnt(0)
    s_barrier
    s_cmp_lg_u32 s3, 2
    s_cbranch_scc1 c_norow6
    s_mov_b32 s64, 6
    s_and_b32 s31, s64, 3
    s_lshl_b32 s31, s31, 10
    v_add_u32 v84, s31, v5
    v_mov_b32 v88, 0
    ds_read_b128 v[84:87], v84 offset:2560
    ds_read_b32 v88, v88 offset:308
    s_lshl_b32 s31, s64, 18
    s_lshl_b32 s33, s2, 4
    s_add_u32 s31, s31, s33
    s_add_u32 s31, s31, 234881024
    s_or_b32 s32, s65, 0x80000000
    s_waitcnt lgkmcnt(0)
    v_or3_b32 v84, v84, s32, v88
    v_or3_b32 v85, v85, s32, v88
    v_or3_b32 v86, v86, s32, v88
    v_or3_b32 v87, v87, s32, v88
    v_lshlrev_b32 v88, 8, v5
    buffer_store_dwordx4 v[84:87], v88, s[8:11], s31 offen sc1
    s_nop 1
c_norow6:
    ds_read_b128 v[48:51], v2 offset:0
    ds_read_b128 v[52:55], v1 offset:8192
    ds_read_b128 v[56:59], v2 offset:16384
    ds_read_b128 v[60:63], v1 offset:24576
    ds_read_b128 v[64:67], v2 offset:32768
    ds_read_b128 v[68:71], v1 offset:40960
    ds_read_b128 v[72:75], v2 offset:49152
    s_cmp_lg_u32 s45, 0
    s_cbranch_scc1 c_zodd
    ds_write_b128 v2, v[80:83] offset:0
    ds_write_b128 v2, v[80:83] offset:16384
    ds_write_b128 v2, v[80:83] offset:32768
    ds_write_b128 v2, v[80:83] offset:49152
    s_branch c_zend
c_zodd:
    ds_write_b128 v1, v[80:83] offset:8192
    ds_write_b128 v1, v[80:83] offset:24576
    ds_write_b128 v1, v[80:83] offset:40960
c_zend:
    v_lshlrev_b32 v16, 4, v0
    s_mov_b32 s88, 0xc1200000
    s_mov_b32 s89, s88
    s_mov_b32 s90, 0x3fb8aa3b
    s_mov_b32 s91, s90
    s_sub_i32 s92, 246, s34
    s_lshl_b32 s92, s92, 23
    s_mov_b32 s93, s92
    s_mov_b32 s37, 96
    s_cmp_ge_u32 s3, 4
    s_cselect_b32 s37, 96, s37
    s_cmp_ge_u32 s3, 8
    s_cselect_b32 s37, 96, s37
    s_cmp_ge_u32 s3, 12
    s_cselect_b32 s37, 96, s37
    v_and_b32 v43, 48, v3
    v_lshl_or_b32 v42, v43, 26, v5
    s_lshl_b32 s31, s39, 18
    s_add_u32 s31, s31, s38
    buffer_load_dword v42, v42, s[8:11], s31 offen sc1
    s_waitcnt lgkmcnt(3)
    s_add_u32 s31, s60, 0
    s_mov_b32 s14, s61
    buffer_store_dwordx4 v[48:51], v19, s[12:15], s31 offen sc1
    s_waitcnt lgkmcnt(0)
    s_barrier
    s_cmp_eq_u32 s36, 0
    s_cbranch_scc1 c_bad0
    s_setprio 3
    v_and_b32 v86, v4, v20
    v_and_b32 v87, v4, v21
    v_xor_b32 v20, v86, v20
    v_xor_b32 v21, v87, v21
    v_dot2_u32_u16 v84, v86, s87, v8
    v_dot2_u32_u16 v84, v87, s85, v84
    v_mfma_f32_4x4x4_16b_f16 v[76:79], v[20:21], v[40:41], v[122:125]
    v_and_b32 v88, v4, v22
    v_and_b32 v89, v4, v23
    v_xor_b32 v22, v88, v22
    v_xor_b32 v23, v89, v23
    v_dot2_u32_u16 v85, v88, s87, v8
    v_dot2_u32_u16 v85, v89, s85, v85
    v_mfma_f32_4x4x4_16b_f16 v[80:83], v[22:23], v[40:41], v[122:125]
    v_add_u32_dpp v86, v84, v17 quad_perm:[0,0,0,0] row_mask:0xf bank_mask:0xf
    ds_add_u32 v86, v76
    v_add_u32_dpp v87, v84, v17 quad_perm:[1,1,1,1] row_mask:0xf bank_mask:0xf
    ds_add_u32 v87, v77
    v_add_u32_dpp v88, v84, v17 quad_perm:[2,2,2,2] row_mask:0xf bank_mask:0xf
    ds_add_u32 v88, v78
    v_add_u32_dpp v89, v84, v17 quad_perm:[3,3,3,3] row_mask:0xf bank_mask:0xf
    ds_add_u32 v89, v79
    v_add_u32_dpp v86, v85, v17 quad_perm:[0,0,0,0] row_mask:0xf bank_mask:0xf
    ds_add_u32 v86, v80
    v_add_u32_dpp v87, v85, v17 quad_perm:[1,1,1,1] row_mask:0xf bank_mask:0xf
    ds_add_u32 v87, v81
    v_add_u32_dpp v88, v85, v17 quad_perm:[2,2,2,2] row_mask:0xf bank_mask:0xf
    ds_add_u32 v88, v82
    v_add_u32_dpp v89, v85, v17 quad_perm:[3,3,3,3] row_mask:0xf bank_mask:0xf
    ds_add_u32 v89, v83
    s_sub_i32 s36, s36, 64
    s_add_u32 s31, s62, 16384
    s_mov_b32 s14, s63
    buffer_store_dwordx4 v[52:55], v19, s[12:15], s31 offen sc1
    v_and_b32 v86, v4, v24
    v_and_b32 v87, v4, v25
    v_xor_b32 v24, v86, v24
    v_xor_b32 v25, v87, v25
    v_dot2_u32_u16 v84, v86, s87, v8
    v_dot2_u32_u16 v84, v87, s85, v84
    v_mfma_f32_4x4x4_16b_f16 v[76:79], v[24:25], v[40:41], v[122:125]
    v_and_b32 v88, v4, v26
    v_and_b32 v89, v4, v27
    v_xor_b32 v26, v88, v26
    v_xor_b32 v27, v89, v27
    v_dot2_u32_u16 v85, v88, s87, v8
    v_dot2_u32_u16 v85, v89, s85, v85
    v_mfma_f32_4x4x4_16b_f16 v[80:83], v[26:27], v[40:41], v[122:125]
    v_add_u32_dpp v86, v84, v17 quad_perm:[0,0,0,0] row_mask:0xf bank_mask:0xf
    ds_add_u32 v86, v76
    v_add_u32_dpp v87, v84, v17 quad_perm:[1,1,1,1] row_mask:0xf bank_mask:0xf
    ds_add_u32 v87, v77
    v_add_u32_dpp v88, v84, v17 quad_perm:[2,2,2,2] row_mask:0xf bank_mask:0xf
    ds_add_u32 v88, v78
    v_add_u32_dpp v89, v84, v17 quad_perm:[3,3,3,3] row_mask:0xf bank_mask:0xf
    ds_add_u32 v89, v79
    v_add_u32_dpp v86, v85, v17 quad_perm:[0,0,0,0] row_mask:0xf bank_mask:0xf
    ds_add_u32 v86, v80
    v_add_u32_dpp v87, v85, v17 quad_perm:[1,1,1,1] row_mask:0xf bank_mask:0xf
    ds_add_u32 v87, v81
    v_add_u32_dpp v88, v85, v17 quad_perm:[2,2,2,2] row_mask:0xf bank_mask:0xf
    ds_add_u32 v88, v82
    v_add_u32_dpp v89, v85, v17 quad_perm:[3,3,3,3] row_mask:0xf bank_mask:0xf
    ds_add_u32 v89, v83
    s_sub_i32 s36, s36, 64
    s_mov_b32 s84, 512
    s_lshl_b32 s33, s39, 4
    s_add_u32 s33, s33, s3
    s_sub_u32 s33, s33, 16
    s_lshl_b32 s33, s33, 20
    v_mul_u32_u24 v78, 57344, v3
    v_add_u32 v78, s33, v78
    s_waitcnt vmcnt(2)
    s_mov_b32 s33, 131072
f_pollc5:
    v_cmp_gt_i32 vcc, 0, v42
    s_cmp_eq_u64 vcc, s[82:83]
    s_cbranch_scc1 f_polledc5
    s_sub_u32 s33, s33, 1
    s_cbranch_scc1 f_done
    s_cmp_ge_u32 s33, 131071
    s_cbranch_scc1 f_noslc5
    s_sleep 32
f_noslc5:
    v_and_b32 v43, 48, v3
    v_lshl_or_b32 v42, v43, 26, v5
    s_lshl_b32 s31, s39, 18
    s_add_u32 s31, s31, s38
    buffer_load_dword v42, v42, s[8:11], s31 offen sc1
    s_waitcnt vmcnt(0)
    s_branch f_pollc5
f_polledc5:
    v_bfe_u32 v80, v42, 13, 13
    v_and_b32 v42, 0x1fff, v42
    v_cmp_lt_u32 vcc, 0, v80
    v_mov_b32 v81, v80
    v_lshl_add_u32 v6, v3, 3, s48
    v_mbcnt_lo_u32_b32 v82, vcc_lo, 0
    s_nop 1
    v_add_u32_dpp v81, v81, v81 row_shr:1 row_mask:0xf bank_mask:0xf
    s_nop 1
    v_add_u32_dpp v81, v81, v81 row_shr:2 row_mask:0xf bank_mask:0xf
    s_nop 1
    v_add_u32_dpp v81, v81, v81 row_shr:4 row_mask:0xf bank_mask:0xf
    s_nop 1
    v_add_u32_dpp v81, v81, v81 row_shr:8 row_mask:0xf bank_mask:0xf
    v_add_lshl_u32 v82, v82, s43, 2
    v_readlane_b32 s33, v81, 15
    v_sub_u32 v81, v81, v80
    v_add_u32 v81, s53, v81
    s_bcnt1_i32_b64 s31, vcc
    s_add_u32 s43, s43, s31
    s_add_u32 s39, s39, 1
    s_add_u32 s53, s53, s33
    s_add_u32 s36, s36, s33
    s_cmp_lt_u32 s53, s84
    s_cselect_b32 s31, -1, s53
    s_cmp_gt_u32 s31, 3072
    s_cselect_b64 s[80:81], -1, 0
    s_cselect_b32 s36, 0, s36
    s_cbranch_scc1 c_nomap5
    v_sub_u32 v42, v42, v81
    v_lshl_add_u32 v78, v42, 4, v78
    v_cmpx_lt_u32 vcc, 0, v80
    ds_write_b32 v82, v78 offset:6656
    v_add3_u32 v76, v81, v80, -1
    v_lshrrev_b32 v77, 3, v76
    v_and_b32 v77, -4, v77
    v_lshlrev_b32 v76, v76, 1
    v_add_u32 v77, s48, v77
    ds_or_b32 v77, v76 offset:15104
    s_mov_b64 exec, -1
c_nomap5:
    ds_read_b64 v[6:7], v6 offset:15104
    s_waitcnt lgkmcnt(0)
    s_mov_b32 s84, 1024
    s_cmp_eq_u32 s36, 0
    s_cbranch_scc1 c_bad1
    v_readlane_b32 s28, v6, s58
    v_readlane_b32 s29, v7, s58
    s_add_u32 s58, s58, 1
    s_nop 0
    v_mbcnt_lo_u32_b32 v90, s28, 0
    v_mbcnt_hi_u32_b32 v90, s29, v90
    s_bcnt1_i32_b64 s31, s[28:29]
    v_add_lshl_u32 v90, v90, s57, 2
    s_add_u32 s57, s57, s31
    ds_read_b32 v76, v90 offset:6656
    v_readlane_b32 s28, v6, s58
    v_readlane_b32 s29, v7, s58
    s_add_u32 s58, s58, 1
    s_nop 0
    v_mbcnt_lo_u32_b32 v90, s28, 0
    v_mbcnt_hi_u32_b32 v90, s29, v90
    s_bcnt1_i32_b64 s31, s[28:29]
    v_add_lshl_u32 v90, v90, s57, 2
    s_add_u32 s57, s57, s31
    ds_read_b32 v78, v90 offset:6656
    v_readlane_b32 s28, v6, s58
    v_readlane_b32 s29, v7, s58
    s_add_u32 s58, s58, 1
    s_nop 0
    v_mbcnt_lo_u32_b32 v90, s28, 0
    v_mbcnt_hi_u32_b32 v90, s29, v90
    s_bcnt1_i32_b64 s31, s[28:29]
    v_add_lshl_u32 v90, v90, s57, 2
    s_add_u32 s57, s57, s31
    ds_read_b32 v14, v90 offset:6656
    s_waitcnt lgkmcnt(0)
    v_add3_u32 v76, v76, v5, s59
    v_and_b32 v90, 0xffffe000, v76
    v_add_u32 v90, v76, v90
    s_add_u32 s59, s59, 0x400
    buffer_load_dwordx4 v[20:23], v90, s[8:11], s55 offen sc1
    v_add3_u32 v78, v78, v5, s59
    v_and_b32 v90, 0xffffe000, v78
    v_add_u32 v90, v78, v90
    s_add_u32 s59, s59, 0x400
    buffer_load_dwordx4 v[24:27], v90, s[8:11], s55 offen sc1
    s_add_u32 s31, s60, 32768
    s_mov_b32 s14, s61
    buffer_store_dwordx4 v[56:59], v19, s[12:15], s31 offen sc1
    v_lshlrev_b32 v82, 16, v92
    v_pk_add_f32 v[76:77], v[82:83], s[66:67] op_sel_hi:[0,1] neg_lo:[0,1] neg_hi:[0,1]
    v_pk_add_f32 v[78:79], v[82:83], s[68:69] op_sel_hi:[0,1] neg_lo:[0,1] neg_hi:[0,1]
    v_pk_add_f32 v[80:81], v[82:83], s[70:71] op_sel_hi:[0,1] neg_lo:[0,1] neg_hi:[0,1]
    v_pk_add_f32 v[82:83], v[82:83], s[72:73] op_sel_hi:[0,1] neg_lo:[0,1] neg_hi:[0,1]
    v_cvt_pk_bf16_f32 v76, 0, v76
    v_cvt_pk_bf16_f32 v77, 0, v77
    v_cvt_pk_bf16_f32 v78, 0, v78
    v_cvt_pk_bf16_f32 v79, 0, v79
    v_cvt_pk_bf16_f32 v80, 0, v80
    v_cvt_pk_bf16_f32 v81, 0, v81
    v_cvt_pk_bf16_f32 v82, 0, v82
    v_cvt_pk_bf16_f32 v83, 0, v83
    v_pk_mul_f32 v[76:77], v[76:77], v[76:77]
    v_pk_mul_f32 v[78:79], v[78:79], v[78:79]
    v_pk_mul_f32 v[80:81], v[80:81], v[80:81]
    v_pk_mul_f32 v[82:83], v[82:83], v[82:83]
    v_cvt_pk_bf16_f32 v76, 0, v76
    v_cvt_pk_bf16_f32 v77, 0, v77
    v_cvt_pk_bf16_f32 v78, 0, v78
    v_cvt_pk_bf16_f32 v79, 0, v79
    v_cvt_pk_bf16_f32 v80, 0, v80
    v_cvt_pk_bf16_f32 v81, 0, v81
    v_cvt_pk_bf16_f32 v82, 0, v82
    v_cvt_pk_bf16_f32 v83, 0, v83
    v_pk_mul_f32 v[76:77], v[76:77], s[88:89]
    v_pk_mul_f32 v[78:79], v[78:79], s[88:89]
    v_pk_mul_f32 v[80:81], v[80:81], s[88:89]
    v_pk_mul_f32 v[82:83], v[82:83], s[88:89]
    v_cvt_pk_bf16_f32 v76, 0, v76
    v_cvt_pk_bf16_f32 v77, 0, v77
    v_cvt_pk_bf16_f32 v78, 0, v78
    v_cvt_pk_bf16_f32 v79, 0, v79
    v_cvt_pk_bf16_f32 v80, 0, v80
    v_cvt_pk_bf16_f32 v81, 0, v81
    v_cvt_pk_bf16_f32 v82, 0, v82
    v_cvt_pk_bf16_f32 v83, 0, v83
    v_pk_mul_f32 v[76:77], v[76:77], s[90:91]
    v_pk_mul_f32 v[78:79], v[78:79], s[90:91]
    v_pk_mul_f32 v[80:81], v[80:81], s[90:91]
    v_pk_mul_f32 v[82:83], v[82:83], s[90:91]
    v_exp_f32 v76, v76
    v_exp_f32 v77, v77
    v_exp_f32 v78, v78
    v_exp_f32 v79, v79
    v_exp_f32 v80, v80
    v_exp_f32 v81, v81
    v_exp_f32 v82, v82
    v_exp_f32 v83, v83
    v_cvt_pk_bf16_f32 v76, v76, v77
    v_cvt_pk_bf16_f32 v77, v78, v79
    v_cvt_pk_bf16_f32 v78, v80, v81
    v_cvt_pk_bf16_f32 v79, v82, v83
    s_nop 0
    v_mfma_f32_4x4x4_16b_bf16 v[44:47], v[116:117], v[76:77], 0
    v_mfma_f32_4x4x4_16b_bf16 v[48:51], v[112:113], v[76:77], 0
    s_nop 0
    v_mfma_f32_4x4x4_16b_bf16 v[44:47], v[118:119], v[78:79], v[44:47]
    v_mfma_f32_4x4x4_16b_bf16 v[48:51], v[114:115], v[78:79], v[48:51]
    v_lshlrev_b32 v96, 16, v98
    v_and_b32 v97, 0xffff0000, v98
    v_lshlrev_b32 v98, 16, v99
    v_and_b32 v99, 0xffff0000, v99
    v_pk_mul_f32 v[44:45], v[44:45], s[92:93]
    v_pk_mul_f32 v[46:47], v[46:47], s[92:93]
    v_cvt_pk_bf16_f32 v48, 0, v48
    v_cvt_pk_bf16_f32 v49, 0, v49
    v_cvt_pk_bf16_f32 v50, 0, v50
    v_cvt_pk_bf16_f32 v51, 0, v51
    s_add_u32 s31, s62, 49152
    s_mov_b32 s14, s63
    buffer_store_dwordx4 v[60:63], v19, s[12:15], s31 offen sc1
    s_add_u32 s31, s60, 65536
    s_mov_b32 s14, s61
    buffer_store_dwordx4 v[64:67], v19, s[12:15], s31 offen sc1
    v_and_b32 v86, v4, v28
    v_and_b32 v87, v4, v29
    v_xor_b32 v28, v86, v28
    v_xor_b32 v29, v87, v29
    v_dot2_u32_u16 v84, v86, s87, v8
    v_dot2_u32_u16 v84, v87, s85, v84
    v_mfma_f32_4x4x4_16b_f16 v[76:79], v[28:29], v[40:41], v[122:125]
    v_and_b32 v88, v4, v30
    v_and_b32 v89, v4, v31
    v_xor_b32 v30, v88, v30
    v_xor_b32 v31, v89, v31
    v_dot2_u32_u16 v85, v88, s87, v8
    v_dot2_u32_u16 v85, v89, s85, v85
    v_mfma_f32_4x4x4_16b_f16 v[80:83], v[30:31], v[40:41], v[122:125]
    v_add_u32_dpp v86, v84, v17 quad_perm:[0,0,0,0] row_mask:0xf bank_mask:0xf
    ds_add_u32 v86, v76
    v_add_u32_dpp v87, v84, v17 quad_perm:[1,1,1,1] row_mask:0xf bank_mask:0xf
    ds_add_u32 v87, v77
    v_add_u32_dpp v88, v84, v17 quad_perm:[2,2,2,2] row_mask:0xf bank_mask:0xf
    ds_add_u32 v88, v78
    v_add_u32_dpp v89, v84, v17 quad_perm:[3,3,3,3] row_mask:0xf bank_mask:0xf
    ds_add_u32 v89, v79
    v_add_u32_dpp v86, v85, v17 quad_perm:[0,0,0,0] row_mask:0xf bank_mask:0xf
    ds_add_u32 v86, v80
    v_add_u32_dpp v87, v85, v17 quad_perm:[1,1,1,1] row_mask:0xf bank_mask:0xf
    ds_add_u32 v87, v81
    v_add_u32_dpp v88, v85, v17 quad_perm:[2,2,2,2] row_mask:0xf bank_mask:0xf
    ds_add_u32 v88, v82
    v_add_u32_dpp v89, v85, v17 quad_perm:[3,3,3,3] row_mask:0xf bank_mask:0xf
    ds_add_u32 v89, v83
    s_sub_i32 s36, s36, 64
    v_lshlrev_b32 v82, 16, v93
    v_pk_add_f32 v[76:77], v[82:83], s[66:67] op_sel_hi:[0,1] neg_lo:[0,1] neg_hi:[0,1]
    v_pk_add_f32 v[78:79], v[82:83], s[68:69] op_sel_hi:[0,1] neg_lo:[0,1] neg_hi:[0,1]
    v_pk_add_f32 v[80:81], v[82:83], s[70:71] op_sel_hi:[0,1] neg_lo:[0,1] neg_hi:[0,1]
    v_pk_add_f32 v[82:83], v[82:83], s[72:73] op_sel_hi:[0,1] neg_lo:[0,1] neg_hi:[0,1]
    v_cvt_pk_bf16_f32 v76, 0, v76
    v_cvt_pk_bf16_f32 v77, 0, v77
    v_cvt_pk_bf16_f32 v78, 0, v78
    v_cvt_pk_bf16_f32 v79, 0, v79
    v_cvt_pk_bf16_f32 v80, 0, v80
    v_cvt_pk_bf16_f32 v81, 0, v81
    v_cvt_pk_bf16_f32 v82, 0, v82
    v_cvt_pk_bf16_f32 v83, 0, v83
    v_pk_mul_f32 v[76:77], v[76:77], v[76:77]
    v_pk_mul_f32 v[78:79], v[78:79], v[78:79]
    v_pk_mul_f32 v[80:81], v[80:81], v[80:81]
    v_pk_mul_f32 v[82:83], v[82:83], v[82:83]
    v_cvt_pk_bf16_f32 v76, 0, v76
    v_cvt_pk_bf16_f32 v77, 0, v77
    v_cvt_pk_bf16_f32 v78, 0, v78
    v_cvt_pk_bf16_f32 v79, 0, v79
    v_cvt_pk_bf16_f32 v80, 0, v80
    v_cvt_pk_bf16_f32 v81, 0, v81
    v_cvt_pk_bf16_f32 v82, 0, v82
    v_cvt_pk_bf16_f32 v83, 0, v83
    v_pk_mul_f32 v[76:77], v[76:77], s[88:89]
    v_pk_mul_f32 v[78:79], v[78:79], s[88:89]
    v_pk_mul_f32 v[80:81], v[80:81], s[88:89]
    v_pk_mul_f32 v[82:83], v[82:83], s[88:89]
    v_cvt_pk_bf16_f32 v76, 0, v76
    v_cvt_pk_bf16_f32 v77, 0, v77
    v_cvt_pk_bf16_f32 v78, 0, v78
    v_cvt_pk_bf16_f32 v79, 0, v79
    v_cvt_pk_bf16_f32 v80, 0, v80
    v_cvt_pk_bf16_f32 v81, 0, v81
    v_cvt_pk_bf16_f32 v82, 0, v82
    v_cvt_pk_bf16_f32 v83, 0, v83
    v_pk_mul_f32 v[76:77], v[76:77], s[90:91]
    v_pk_mul_f32 v[78:79], v[78:79], s[90:91]
    v_pk_mul_f32 v[80:81], v[80:81], s[90:91]
    v_pk_mul_f32 v[82:83], v[82:83], s[90:91]
    v_exp_f32 v76, v76
    v_exp_f32 v77, v77
    v_exp_f32 v78, v78
    v_exp_f32 v79, v79
    v_exp_f32 v80, v80
    v_exp_f32 v81, v81
    v_exp_f32 v82, v82
    v_exp_f32 v83, v83
    v_cvt_pk_bf16_f32 v76, v76, v77
    v_cvt_pk_bf16_f32 v77, v78, v79
    v_cvt_pk_bf16_f32 v78, v80, v81
    v_cvt_pk_bf16_f32 v79, v82, v83
    s_nop 0
    v_mfma_f32_4x4x4_16b_bf16 v[52:55], v[116:117], v[76:77], 0
    v_mfma_f32_4x4x4_16b_bf16 v[56:59], v[112:113], v[76:77], 0
    s_nop 0
    v_mfma_f32_4x4x4_16b_bf16 v[52:55], v[118:119], v[78:79], v[52:55]
    v_mfma_f32_4x4x4_16b_bf16 v[56:59], v[114:115], v[78:79], v[56:59]
    v_lshlrev_b32 v100, 16, v102
    v_and_b32 v101, 0xffff0000, v102
    v_lshlrev_b32 v102, 16, v103
    v_and_b32 v103, 0xffff0000, v103
    v_pk_mul_f32 v[52:53], v[52:53], s[92:93]
    v_pk_mul_f32 v[54:55], v[54:55], s[92:93]
    v_cvt_pk_bf16_f32 v56, 0, v56
    v_cvt_pk_bf16_f32 v57, 0, v57
    v_cvt_pk_bf16_f32 v58, 0, v58
    v_cvt_pk_bf16_f32 v59, 0, v59
    s_add_u32 s31, s62, 81920
    s_mov_b32 s14, s63
    buffer_store_dwordx4 v[68:71], v19, s[12:15], s31 offen sc1
    s_add_u32 s31, s60, 98304
    s_mov_b32 s14, s61
    buffer_store_dwordx4 v[72:75], v19, s[12:15], s31 offen sc1
    v_and_b32 v86, v4, v32
    v_and_b32 v87, v4, v33
    v_xor_b32 v32, v86, v32
    v_xor_b32 v33, v87, v33
    v_dot2_u32_u16 v84, v86, s87, v8
    v_dot2_u32_u16 v84, v87, s85, v84
    v_mfma_f32_4x4x4_16b_f16 v[76:79], v[32:33], v[40:41], v[122:125]
    v_and_b32 v88, v4, v34
    v_and_b32 v89, v4, v35
    v_xor_b32 v34, v88, v34
    v_xor_b32 v35, v89, v35
    v_dot2_u32_u16 v85, v88, s87, v8
    v_dot2_u32_u16 v85, v89, s85, v85
    v_mfma_f32_4x4x4_16b_f16 v[80:83], v[34:35], v[40:41], v[122:125]
    v_add_u32_dpp v86, v84, v17 quad_perm:[0,0,0,0] row_mask:0xf bank_mask:0xf
    ds_add_u32 v86, v76
    v_add_u32_dpp v87, v84, v17 quad_perm:[1,1,1,1] row_mask:0xf bank_mask:0xf
    ds_add_u32 v87, v77
    v_add_u32_dpp v88, v84, v17 quad_perm:[2,2,2,2] row_mask:0xf bank_mask:0xf
    ds_add_u32 v88, v78
    v_add_u32_dpp v89, v84, v17 quad_perm:[3,3,3,3] row_mask:0xf bank_mask:0xf
    ds_add_u32 v89, v79
    v_add_u32_dpp v86, v85, v17 quad_perm:[0,0,0,0] row_mask:0xf bank_mask:0xf
    ds_add_u32 v86, v80
    v_add_u32_dpp v87, v85, v17 quad_perm:[1,1,1,1] row_mask:0xf bank_mask:0xf
    ds_add_u32 v87, v81
    v_add_u32_dpp v88, v85, v17 quad_perm:[2,2,2,2] row_mask:0xf bank_mask:0xf
    ds_add_u32 v88, v82
    v_add_u32_dpp v89, v85, v17 quad_perm:[3,3,3,3] row_mask:0xf bank_mask:0xf
    ds_add_u32 v89, v83
    s_sub_i32 s36, s36, 64
    s_waitcnt vmcnt(0)
    v_mov_b32 v91, 1
    v_mov_b32 v90, 0
    s_mov_b64 exec, 1
    ds_add_rtn_u32 v90, v90, v91 offset:288
    s_mov_b64 exec, -1
    s_waitcnt lgkmcnt(0)
    v_readfirstlane_b32 s95, v90
    s_nop 0
    s_cmp_lg_u32 s95, 15
    s_cbranch_scc1 c_norow7a
    s_mov_b32 s64, 7
    s_and_b32 s31, s64, 3
    s_lshl_b32 s31, s31, 10
    v_add_u32 v76, s31, v5
    v_mov_b32 v80, 0
    ds_read_b128 v[76:79], v76 offset:2560
    ds_read_b32 v80, v80 offset:308
    s_lshl_b32 s31, s64, 18
    s_lshl_b32 s33, s2, 4
    s_add_u32 s31, s31, s33
    s_add_u32 s31, s31, 234881024
    s_or_b32 s32, s65, 0x80000000
    s_waitcnt lgkmcnt(0)
    v_or3_b32 v76, v76, s32, v80
    v_or3_b32 v77, v77, s32, v80
    v_or3_b32 v78, v78, s32, v80
    v_or3_b32 v79, v79, s32, v80
    v_lshlrev_b32 v80, 8, v5
    buffer_store_dwordx4 v[76:79], v80, s[8:11], s31 offen sc1
    s_nop 1
c_norow7a:
    s_setprio 2
    v_lshlrev_b32 v82, 16, v94
    v_pk_add_f32 v[76:77], v[82:83], s[66:67] op_sel_hi:[0,1] neg_lo:[0,1] neg_hi:[0,1]
    v_pk_add_f32 v[78:79], v[82:83], s[68:69] op_sel_hi:[0,1] neg_lo:[0,1] neg_hi:[0,1]
    v_pk_add_f32 v[80:81], v[82:83], s[70:71] op_sel_hi:[0,1] neg_lo:[0,1] neg_hi:[0,1]
    v_pk_add_f32 v[82:83], v[82:83], s[72:73] op_sel_hi:[0,1] neg_lo:[0,1] neg_hi:[0,1]
    v_cvt_pk_bf16_f32 v76, 0, v76
    v_cvt_pk_bf16_f32 v77, 0, v77
    v_cvt_pk_bf16_f32 v78, 0, v78
    v_cvt_pk_bf16_f32 v79, 0, v79
    v_cvt_pk_bf16_f32 v80, 0, v80
    v_cvt_pk_bf16_f32 v81, 0, v81
    v_cvt_pk_bf16_f32 v82, 0, v82
    v_cvt_pk_bf16_f32 v83, 0, v83
    v_pk_mul_f32 v[76:77], v[76:77], v[76:77]
    v_pk_mul_f32 v[78:79], v[78:79], v[78:79]
    v_pk_mul_f32 v[80:81], v[80:81], v[80:81]
    v_pk_mul_f32 v[82:83], v[82:83], v[82:83]
    v_cvt_pk_bf16_f32 v76, 0, v76
    v_cvt_pk_bf16_f32 v77, 0, v77
    v_cvt_pk_bf16_f32 v78, 0, v78
    v_cvt_pk_bf16_f32 v79, 0, v79
    v_cvt_pk_bf16_f32 v80, 0, v80
    v_cvt_pk_bf16_f32 v81, 0, v81
    v_cvt_pk_bf16_f32 v82, 0, v82
    v_cvt_pk_bf16_f32 v83, 0, v83
    v_pk_mul_f32 v[76:77], v[76:77], s[88:89]
    v_pk_mul_f32 v[78:79], v[78:79], s[88:89]
    v_pk_mul_f32 v[80:81], v[80:81], s[88:89]
    v_pk_mul_f32 v[82:83], v[82:83], s[88:89]
    v_cvt_pk_bf16_f32 v76, 0, v76
    v_cvt_pk_bf16_f32 v77, 0, v77
    v_cvt_pk_bf16_f32 v78, 0, v78
    v_cvt_pk_bf16_f32 v79, 0, v79
    v_cvt_pk_bf16_f32 v80, 0, v80
    v_cvt_pk_bf16_f32 v81, 0, v81
    v_cvt_pk_bf16_f32 v82, 0, v82
    v_cvt_pk_bf16_f32 v83, 0, v83
    v_pk_mul_f32 v[76:77], v[76:77], s[90:91]
    v_pk_mul_f32 v[78:79], v[78:79], s[90:91]
    v_pk_mul_f32 v[80:81], v[80:81], s[90:91]
    v_pk_mul_f32 v[82:83], v[82:83], s[90:91]
    v_exp_f32 v76, v76
    v_exp_f32 v77, v77
    v_exp_f32 v78, v78
    v_exp_f32 v79, v79
    v_exp_f32 v80, v80
    v_exp_f32 v81, v81
    v_exp_f32 v82, v82
    v_exp_f32 v83, v83
    v_cvt_pk_bf16_f32 v76, v76, v77
    v_cvt_pk_bf16_f32 v77, v78, v79
    v_cvt_pk_bf16_f32 v78, v80, v81
    v_cvt_pk_bf16_f32 v79, v82, v83
    s_nop 0
    v_mfma_f32_4x4x4_16b_bf16 v[60:63], v[116:117], v[76:77], 0
    v_mfma_f32_4x4x4_16b_bf16 v[64:67], v[112:113], v[76:77], 0
    s_nop 0
    v_mfma_f32_4x4x4_16b_bf16 v[60:63], v[118:119], v[78:79], v[60:63]
    v_mfma_f32_4x4x4_16b_bf16 v[64:67], v[114:115], v[78:79], v[64:67]
    v_lshlrev_b32 v104, 16, v106
    v_and_b32 v105, 0xffff0000, v106
    v_lshlrev_b32 v106, 16, v107
    v_and_b32 v107, 0xffff0000, v107
    v_pk_mul_f32 v[60:61], v[60:61], s[92:93]
    v_pk_mul_f32 v[62:63], v[62:63], s[92:93]
    v_cvt_pk_bf16_f32 v64, 0, v64
    v_cvt_pk_bf16_f32 v65, 0, v65
    v_cvt_pk_bf16_f32 v66, 0, v66
    v_cvt_pk_bf16_f32 v67, 0, v67
    v_and_b32 v43, 48, v3
    v_lshl_or_b32 v42, v43, 26, v5
    s_lshl_b32 s31, s39, 18
    s_add_u32 s31, s31, s38
    buffer_load_dword v42, v42, s[8:11], s31 offen sc1
    v_and_b32 v86, v4, v36
    v_and_b32 v87, v4, v37
    v_xor_b32 v36, v86, v36
    v_xor_b32 v37, v87, v37
    v_dot2_u32_u16 v84, v86, s87, v8
    v_dot2_u32_u16 v84, v87, s85, v84
    v_mfma_f32_4x4x4_16b_f16 v[76:79], v[36:37], v[40:41], v[122:125]
    v_and_b32 v88, v4, v38
    v_and_b32 v89, v4, v39
    v_xor_b32 v38, v88, v38
    v_xor_b32 v39, v89, v39
    v_dot2_u32_u16 v85, v88, s87, v8
    v_dot2_u32_u16 v85, v89, s85, v85
    v_mfma_f32_4x4x4_16b_f16 v[80:83], v[38:39], v[40:41], v[122:125]
    v_add_u32_dpp v86, v84, v17 quad_perm:[0,0,0,0] row_mask:0xf bank_mask:0xf
    ds_add_u32 v86, v76
    v_add_u32_dpp v87, v84, v17 quad_perm:[1,1,1,1] row_mask:0xf bank_mask:0xf
    ds_add_u32 v87, v77
    v_add_u32_dpp v88, v84, v17 quad_perm:[2,2,2,2] row_mask:0xf bank_mask:0xf
    ds_add_u32 v88, v78
    v_add_u32_dpp v89, v84, v17 quad_perm:[3,3,3,3] row_mask:0xf bank_mask:0xf
    ds_add_u32 v89, v79
    v_add_u32_dpp v86, v85, v17 quad_perm:[0,0,0,0] row_mask:0xf bank_mask:0xf
    ds_add_u32 v86, v80
    v_add_u32_dpp v87, v85, v17 quad_perm:[1,1,1,1] row_mask:0xf bank_mask:0xf
    ds_add_u32 v87, v81
    v_add_u32_dpp v88, v85, v17 quad_perm:[2,2,2,2] row_mask:0xf bank_mask:0xf
    ds_add_u32 v88, v82
    v_add_u32_dpp v89, v85, v17 quad_perm:[3,3,3,3] row_mask:0xf bank_mask:0xf
    ds_add_u32 v89, v83
    s_sub_i32 s36, s36, 64
    s_cmp_lg_u32 s3, 0
    s_cbranch_scc1 c_rbf31
    v_lshlrev_b32 v82, 16, v95
    v_pk_add_f32 v[76:77], v[82:83], s[66:67] op_sel_hi:[0,1] neg_lo:[0,1] neg_hi:[0,1]
    v_pk_add_f32 v[78:79], v[82:83], s[68:69] op_sel_hi:[0,1] neg_lo:[0,1] neg_hi:[0,1]
    v_pk_add_f32 v[80:81], v[82:83], s[70:71] op_sel_hi:[0,1] neg_lo:[0,1] neg_hi:[0,1]
    v_pk_add_f32 v[82:83], v[82:83], s[72:73] op_sel_hi:[0,1] neg_lo:[0,1] neg_hi:[0,1]
    v_cvt_pk_bf16_f32 v76, 0, v76
    v_cvt_pk_bf16_f32 v77, 0, v77
    v_cvt_pk_bf16_f32 v78, 0, v78
    v_cvt_pk_bf16_f32 v79, 0, v79
    v_cvt_pk_bf16_f32 v80, 0, v80
    v_cvt_pk_bf16_f32 v81, 0, v81
    v_cvt_pk_bf16_f32 v82, 0, v82
    v_cvt_pk_bf16_f32 v83, 0, v83
    v_pk_mul_f32 v[76:77], v[76:77], v[76:77]
    v_pk_mul_f32 v[78:79], v[78:79], v[78:79]
    v_pk_mul_f32 v[80:81], v[80:81], v[80:81]
    v_pk_mul_f32 v[82:83], v[82:83], v[82:83]
    v_cvt_pk_bf16_f32 v76, 0, v76
    v_cvt_pk_bf16_f32 v77, 0, v77
    v_cvt_pk_bf16_f32 v78, 0, v78
    v_cvt_pk_bf16_f32 v79, 0, v79
    v_cvt_pk_bf16_f32 v80, 0, v80
    v_cvt_pk_bf16_f32 v81, 0, v81
    v_cvt_pk_bf16_f32 v82, 0, v82
    v_cvt_pk_bf16_f32 v83, 0, v83
    v_pk_mul_f32 v[76:77], v[76:77], s[88:89]
    v_pk_mul_f32 v[78:79], v[78:79], s[88:89]
    v_pk_mul_f32 v[80:81], v[80:81], s[88:89]
    v_pk_mul_f32 v[82:83], v[82:83], s[88:89]
    v_cvt_pk_bf16_f32 v76, 0, v76
    v_cvt_pk_bf16_f32 v77, 0, v77
    v_cvt_pk_bf16_f32 v78, 0, v78
    v_cvt_pk_bf16_f32 v79, 0, v79
    v_cvt_pk_bf16_f32 v80, 0, v80
    v_cvt_pk_bf16_f32 v81, 0, v81
    v_cvt_pk_bf16_f32 v82, 0, v82
    v_cvt_pk_bf16_f32 v83, 0, v83
    v_pk_mul_f32 v[76:77], v[76:77], s[90:91]
    v_pk_mul_f32 v[78:79], v[78:79], s[90:91]
    v_pk_mul_f32 v[80:81], v[80:81], s[90:91]
    v_pk_mul_f32 v[82:83], v[82:83], s[90:91]
    v_exp_f32 v76, v76
    v_exp_f32 v77, v77
    v_exp_f32 v78, v78
    v_exp_f32 v79, v79
    v_exp_f32 v80, v80
    v_exp_f32 v81, v81
    v_exp_f32 v82, v82
    v_exp_f32 v83, v83
    v_cvt_pk_bf16_f32 v76, v76, v77
    v_cvt_pk_bf16_f32 v77, v78, v79
    v_cvt_pk_bf16_f32 v78, v80, v81
    v_cvt_pk_bf16_f32 v79, v82, v83
    s_nop 0
    v_mfma_f32_4x4x4_16b_bf16 v[68:71], v[116:117], v[76:77], 0
    v_mfma_f32_4x4x4_16b_bf16 v[72:75], v[112:113], v[76:77], 0
    s_nop 0
    v_mfma_f32_4x4x4_16b_bf16 v[68:71], v[118:119], v[78:79], v[68:71]
    v_mfma_f32_4x4x4_16b_bf16 v[72:75], v[114:115], v[78:79], v[72:75]
    v_lshlrev_b32 v108, 16, v110
    v_and_b32 v109, 0xffff0000, v110
    v_lshlrev_b32 v110, 16, v111
    v_and_b32 v111, 0xffff0000, v111
    v_pk_mul_f32 v[68:69], v[68:69], s[92:93]
    v_pk_mul_f32 v[70:71], v[70:71], s[92:93]
    v_cvt_pk_bf16_f32 v72, 0, v72
    v_cvt_pk_bf16_f32 v73, 0, v73
    v_cvt_pk_bf16_f32 v74, 0, v74
    v_cvt_pk_bf16_f32 v75, 0, v75
c_rbf31:
    s_lshl_b32 s33, s39, 4
    s_add_u32 s33, s33, s3
    s_sub_u32 s33, s33, 16
    s_lshl_b32 s33, s33, 20
    v_mul_u32_u24 v78, 57344, v3
    v_add_u32 v78, s33, v78
    s_waitcnt vmcnt(0)
    s_mov_b32 s33, 131072
f_pollc6p:
    v_cmp_gt_i32 vcc, 0, v42
    s_cmp_eq_u64 vcc, s[82:83]
    s_cbranch_scc1 f_polledc6p
    s_sub_u32 s33, s33, 1
    s_cbranch_scc1 f_done
    s_cmp_ge_u32 s33, 131071
    s_cbranch_scc1 f_noslc6p
    s_sleep 32
f_noslc6p:
    v_and_b32 v43, 48, v3
    v_lshl_or_b32 v42, v43, 26, v5
    s_lshl_b32 s31, s39, 18
    s_add_u32 s31, s31, s38
    buffer_load_dword v42, v42, s[8:11], s31 offen sc1
    s_waitcnt vmcnt(0)
    s_branch f_pollc6p
f_polledc6p:
    v_bfe_u32 v80, v42, 13, 13
    v_and_b32 v42, 0x1fff, v42
    v_cmp_lt_u32 vcc, 0, v80
    v_mov_b32 v81, v80
    v_lshl_add_u32 v6, v3, 3, s48
    v_mbcnt_lo_u32_b32 v82, vcc_lo, 0
    s_nop 1
    v_add_u32_dpp v81, v81, v81 row_shr:1 row_mask:0xf bank_mask:0xf
    s_nop 1
    v_add_u32_dpp v81, v81, v81 row_shr:2 row_mask:0xf bank_mask:0xf
    s_nop 1
    v_add_u32_dpp v81, v81, v81 row_shr:4 row_mask:0xf bank_mask:0xf
    s_nop 1
    v_add_u32_dpp v81, v81, v81 row_shr:8 row_mask:0xf bank_mask:0xf
    v_add_lshl_u32 v82, v82, s43, 2
    v_readlane_b32 s33, v81, 15
    v_sub_u32 v81, v81, v80
    v_add_u32 v81, s53, v81
    s_bcnt1_i32_b64 s31, vcc
    s_add_u32 s43, s43, s31
    s_add_u32 s39, s39, 1
    s_add_u32 s53, s53, s33
    s_add_u32 s36, s36, s33
    s_cmp_lt_u32 s53, s84
    s_cselect_b32 s31, -1, s53
    s_cmp_gt_u32 s31, 3072
    s_cselect_b64 s[80:81], -1, 0
    s_cselect_b32 s36, 0, s36
    s_cbranch_scc1 c_nomap6p
    v_sub_u32 v42, v42, v81
    v_lshl_add_u32 v78, v42, 4, v78
    v_cmpx_lt_u32 vcc, 0, v80
    ds_write_b32 v82, v78 offset:6656
    v_add3_u32 v76, v81, v80, -1
    v_lshrrev_b32 v77, 3, v76
    v_and_b32 v77, -4, v77
    v_lshlrev_b32 v76, v76, 1
    v_add_u32 v77, s48, v77
    ds_or_b32 v77, v76 offset:15104
    s_mov_b64 exec, -1
c_nomap6p:
    ds_read_b64 v[6:7], v6 offset:15104
    s_waitcnt lgkmcnt(0)
c_loop:
    s_cmp_lt_i32 s36, 64
    s_cbranch_scc1 c_part0
c_back0:
    v_readlane_b32 s28, v6, s58
    v_readlane_b32 s29, v7, s58
    s_add_u32 s58, s58, 1
    s_waitcnt vmcnt(1)
    v_and_b32 v86, v4, v20
    v_and_b32 v87, v4, v21
    v_xor_b32 v20, v86, v20
    v_xor_b32 v21, v87, v21
    v_dot2_u32_u16 v84, v86, s87, v8
    v_dot2_u32_u16 v84, v87, s85, v84
    v_mfma_f32_4x4x4_16b_f16 v[76:79], v[20:21], v[40:41], v[122:125]
    v_and_b32 v88, v4, v22
    v_and_b32 v89, v4, v23
    v_xor_b32 v22, v88, v22
    v_xor_b32 v23, v89, v23
    v_dot2_u32_u16 v85, v88, s87, v8
    v_dot2_u32_u16 v85, v89, s85, v85
    v_mfma_f32_4x4x4_16b_f16 v[80:83], v[22:23], v[40:41], v[122:125]
    v_add_u32_dpp v86, v84, v17 quad_perm:[0,0,0,0] row_mask:0xf bank_mask:0xf
    ds_add_u32 v86, v76
    v_add_u32_dpp v87, v84, v17 quad_perm:[1,1,1,1] row_mask:0xf bank_mask:0xf
    ds_add_u32 v87, v77
    v_add_u32_dpp v88, v84, v17 quad_perm:[2,2,2,2] row_mask:0xf bank_mask:0xf
    ds_add_u32 v88, v78
    v_add_u32_dpp v89, v84, v17 quad_perm:[3,3,3,3] row_mask:0xf bank_mask:0xf
    ds_add_u32 v89, v79
    s_waitcnt lgkmcnt(8)
    v_add3_u32 v14, v14, v5, s59
    v_and_b32 v90, v9, v14
    v_add_u32 v90, v14, v90
    s_add_u32 s59, s59, 0x400
    buffer_load_dwordx4 v[20:23], v90, s[8:11], s55 offen sc1
    v_mbcnt_lo_u32_b32 v91, s28, 0
    v_mbcnt_hi_u32_b32 v91, s29, v91
    s_bcnt1_i32_b64 s31, s[28:29]
    v_add_lshl_u32 v91, v91, s57, 2
    s_add_u32 s57, s57, s31
    ds_read_b32 v14, v91 offset:6656
    v_add_u32_dpp v86, v85, v17 quad_perm:[0,0,0,0] row_mask:0xf bank_mask:0xf
    ds_add_u32 v86, v80
    v_add_u32_dpp v87, v85, v17 quad_perm:[1,1,1,1] row_mask:0xf bank_mask:0xf
    ds_add_u32 v87, v81
    v_add_u32_dpp v88, v85, v17 quad_perm:[2,2,2,2] row_mask:0xf bank_mask:0xf
    ds_add_u32 v88, v82
    v_add_u32_dpp v89, v85, v17 quad_perm:[3,3,3,3] row_mask:0xf bank_mask:0xf
    ds_add_u32 v89, v83
    s_sub_i32 s36, s36, 64
    s_cmp_lt_i32 s36, 64
    s_cbranch_scc1 c_part1
c_back1:
    v_readlane_b32 s28, v6, s58
    v_readlane_b32 s29, v7, s58
    s_add_u32 s58, s58, 1
    s_waitcnt vmcnt(1)
    v_and_b32 v86, v4, v24
    v_and_b32 v87, v4, v25
    v_xor_b32 v24, v86, v24
    v_xor_b32 v25, v87, v25
    v_dot2_u32_u16 v84, v86, s87, v8
    v_dot2_u32_u16 v84, v87, s85, v84
    v_mfma_f32_4x4x4_16b_f16 v[76:79], v[24:25], v[40:41], v[122:125]
    v_and_b32 v88, v4, v26
    v_and_b32 v89, v4, v27
    v_xor_b32 v26, v88, v26
    v_xor_b32 v27, v89, v27
    v_dot2_u32_u16 v85, v88, s87, v8
    v_dot2_u32_u16 v85, v89, s85, v85
    v_mfma_f32_4x4x4_16b_f16 v[80:83], v[26:27], v[40:41], v[122:125]
    v_add_u32_dpp v86, v84, v17 quad_perm:[0,0,0,0] row_mask:0xf bank_mask:0xf
    ds_add_u32 v86, v76
    v_add_u32_dpp v87, v84, v17 quad_perm:[1,1,1,1] row_mask:0xf bank_mask:0xf
    ds_add_u32 v87, v77
    v_add_u32_dpp v88, v84, v17 quad_perm:[2,2,2,2] row_mask:0xf bank_mask:0xf
    ds_add_u32 v88, v78
    v_add_u32_dpp v89, v84, v17 quad_perm:[3,3,3,3] row_mask:0xf bank_mask:0xf
    ds_add_u32 v89, v79
    s_waitcnt lgkmcnt(8)
    v_add3_u32 v14, v14, v5, s59
    v_and_b32 v90, v9, v14
    v_add_u32 v90, v14, v90
    s_add_u32 s59, s59, 0x400
    buffer_load_dwordx4 v[24:27], v90, s[8:11], s55 offen sc1
    v_mbcnt_lo_u32_b32 v91, s28, 0
    v_mbcnt_hi_u32_b32 v91, s29, v91
    s_bcnt1_i32_b64 s31, s[28:29]
    v_add_lshl_u32 v91, v91, s57, 2
    s_add_u32 s57, s57, s31
    ds_read_b32 v14, v91 offset:6656
    v_add_u32_dpp v86, v85, v17 quad_perm:[0,0,0,0] row_mask:0xf bank_mask:0xf
    ds_add_u32 v86, v80
    v_add_u32_dpp v87, v85, v17 quad_perm:[1,1,1,1] row_mask:0xf bank_mask:0xf
    ds_add_u32 v87, v81
    v_add_u32_dpp v88, v85, v17 quad_perm:[2,2,2,2] row_mask:0xf bank_mask:0xf
    ds_add_u32 v88, v82
    v_add_u32_dpp v89, v85, v17 quad_perm:[3,3,3,3] row_mask:0xf bank_mask:0xf
    ds_add_u32 v89, v83
    s_sub_i32 s36, s36, 64
    s_and_b32 s31, s37, 3
    s_cbranch_scc1 c_hook
c_resume:
    s_lshr_b32 s37, s37, 2
    s_cmp_lt_u32 s58, 0
    s_cbranch_scc1 c_loop
    s_setprio 2
    s_cmp_lt_u32 s58, 18
    s_cbranch_scc1 c_loop
    s_setprio 1
    s_cmp_lt_u32 s58, 24
    s_cbranch_scc1 c_loop
    s_setprio 0
    s_branch c_loop
c_hook:
    s_cmp_eq_u32 s31, 1
    s_cbranch_scc1 c_app
    v_and_b32 v43, 48, v3
    v_lshl_or_b32 v42, v43, 26, v5
    s_lshl_b32 s31, s39, 18
    s_add_u32 s31, s31, s38
    buffer_load_dword v42, v42, s[8:11], s31 offen sc1
    s_branch c_resume
c_app:
    s_lshl_b32 s33, s39, 4
    s_add_u32 s33, s33, s3
    s_sub_u32 s33, s33, 16
    s_lshl_b32 s33, s33, 20
    v_mul_u32_u24 v78, 57344, v3
    v_add_u32 v78, s33, v78
    s_mov_b32 s33, 131072
f_pollc6:
    v_cmp_gt_i32 vcc, 0, v42
    s_cmp_eq_u64 vcc, s[82:83]
    s_cbranch_scc1 f_polledc6
    s_sub_u32 s33, s33, 1
    s_cbranch_scc1 f_done
    s_cmp_ge_u32 s33, 131071
    s_cbranch_scc1 f_noslc6
    s_sleep 32
f_noslc6:
    v_and_b32 v43, 48, v3
    v_lshl_or_b32 v42, v43, 26, v5
    s_lshl_b32 s31, s39, 18
    s_add_u32 s31, s31, s38
    buffer_load_dword v42, v42, s[8:11], s31 offen sc1
    s_waitcnt vmcnt(0)
    s_branch f_pollc6
f_polledc6:
    v_bfe_u32 v80, v42, 13, 13
    v_and_b32 v42, 0x1fff, v42
    v_cmp_lt_u32 vcc, 0, v80
    v_mov_b32 v81, v80
    v_lshl_add_u32 v6, v3, 3, s48
    v_mbcnt_lo_u32_b32 v82, vcc_lo, 0
    s_nop 1
    v_add_u32_dpp v81, v81, v81 row_shr:1 row_mask:0xf bank_mask:0xf
    s_nop 1
    v_add_u32_dpp v81, v81, v81 row_shr:2 row_mask:0xf bank_mask:0xf
    s_nop 1
    v_add_u32_dpp v81, v81, v81 row_shr:4 row_mask:0xf bank_mask:0xf
    s_nop 1
    v_add_u32_dpp v81, v81, v81 row_shr:8 row_mask:0xf bank_mask:0xf
    v_add_lshl_u32 v82, v82, s43, 2
    v_readlane_b32 s33, v81, 15
    v_sub_u32 v81, v81, v80
    v_add_u32 v81, s53, v81
    s_bcnt1_i32_b64 s31, vcc
    s_add_u32 s43, s43, s31
    s_add_u32 s39, s39, 1
    s_add_u32 s53, s53, s33
    s_add_u32 s36, s36, s33
    s_cmp_lt_u32 s53, s84
    s_cselect_b32 s31, -1, s53
    s_cmp_gt_u32 s31, 3072
    s_cselect_b64 s[80:81], -1, 0
    s_cselect_b32 s36, 0, s36
    s_cbranch_scc1 c_nomap6
    v_sub_u32 v42, v42, v81
    v_lshl_add_u32 v78, v42, 4, v78
    v_cmpx_lt_u32 vcc, 0, v80
    ds_write_b32 v82, v78 offset:6656
    v_add3_u32 v76, v81, v80, -1
    v_lshrrev_b32 v77, 3, v76
    v_and_b32 v77, -4, v77
    v_lshlrev_b32 v76, v76, 1
    v_add_u32 v77, s48, v77
    ds_or_b32 v77, v76 offset:15104
    s_mov_b64 exec, -1
c_nomap6:
    ds_read_b64 v[6:7], v6 offset:15104
    s_waitcnt lgkmcnt(0)
    s_branch c_resume
c_part0:
    s_cmp_lt_i32 s36, 1
    s_cbranch_scc1 c_loopdone
    s_sub_u32 s53, s53, s36
    s_add_u32 s53, s53, 64
    s_lshl_b64 exec, -1, s36
    s_waitcnt vmcnt(1)
    v_and_b32 v20, 7, v3
    v_lshrrev_b32 v21, 3, v3
    v_or_b32 v20, 131072, v20
    v_or_b32 v21, 393216, v21
    v_mov_b32 v22, v20
    v_mov_b32 v23, v21
    s_mov_b64 exec, -1
    s_branch c_back0
c_part1:
    s_cmp_lt_i32 s36, 1
    s_cbranch_scc1 c_loopdone
    s_sub_u32 s53, s53, s36
    s_add_u32 s53, s53, 64
    s_lshl_b64 exec, -1, s36
    s_waitcnt vmcnt(1)
    v_and_b32 v24, 7, v3
    v_lshrrev_b32 v25, 3, v3
    v_or_b32 v24, 131072, v24
    v_or_b32 v25, 393216, v25
    v_mov_b32 v26, v24
    v_mov_b32 v27, v25
    s_mov_b64 exec, -1
    s_branch c_back1
c_bad0:
    s_waitcnt vmcnt(0)
    s_add_u32 s31, s62, 16384
    s_mov_b32 s14, s63
    buffer_store_dwordx4 v[52:55], v19, s[12:15], s31 offen sc1
c_bad1:
    s_waitcnt vmcnt(0)
    s_add_u32 s31, s60, 32768
    s_mov_b32 s14, s61
    buffer_store_dwordx4 v[56:59], v19, s[12:15], s31 offen sc1
    v_lshlrev_b32 v82, 16, v92
    v_pk_add_f32 v[76:77], v[82:83], s[66:67] op_sel_hi:[0,1] neg_lo:[0,1] neg_hi:[0,1]
    v_pk_add_f32 v[78:79], v[82:83], s[68:69] op_sel_hi:[0,1] neg_lo:[0,1] neg_hi:[0,1]
    v_pk_add_f32 v[80:81], v[82:83], s[70:71] op_sel_hi:[0,1] neg_lo:[0,1] neg_hi:[0,1]
    v_pk_add_f32 v[82:83], v[82:83], s[72:73] op_sel_hi:[0,1] neg_lo:[0,1] neg_hi:[0,1]
    v_cvt_pk_bf16_f32 v76, 0, v76
    v_cvt_pk_bf16_f32 v77, 0, v77
    v_cvt_pk_bf16_f32 v78, 0, v78
    v_cvt_pk_bf16_f32 v79, 0, v79
    v_cvt_pk_bf16_f32 v80, 0, v80
    v_cvt_pk_bf16_f32 v81, 0, v81
    v_cvt_pk_bf16_f32 v82, 0, v82
    v_cvt_pk_bf16_f32 v83, 0, v83
    v_pk_mul_f32 v[76:77], v[76:77], v[76:77]
    v_pk_mul_f32 v[78:79], v[78:79], v[78:79]
    v_pk_mul_f32 v[80:81], v[80:81], v[80:81]
    v_pk_mul_f32 v[82:83], v[82:83], v[82:83]
    v_cvt_pk_bf16_f32 v76, 0, v76
    v_cvt_pk_bf16_f32 v77, 0, v77
    v_cvt_pk_bf16_f32 v78, 0, v78
    v_cvt_pk_bf16_f32 v79, 0, v79
    v_cvt_pk_bf16_f32 v80, 0, v80
    v_cvt_pk_bf16_f32 v81, 0, v81
    v_cvt_pk_bf16_f32 v82, 0, v82
    v_cvt_pk_bf16_f32 v83, 0, v83
    v_pk_mul_f32 v[76:77], v[76:77], s[88:89]
    v_pk_mul_f32 v[78:79], v[78:79], s[88:89]
    v_pk_mul_f32 v[80:81], v[80:81], s[88:89]
    v_pk_mul_f32 v[82:83], v[82:83], s[88:89]
    v_cvt_pk_bf16_f32 v76, 0, v76
    v_cvt_pk_bf16_f32 v77, 0, v77
    v_cvt_pk_bf16_f32 v78, 0, v78
    v_cvt_pk_bf16_f32 v79, 0, v79
    v_cvt_pk_bf16_f32 v80, 0, v80
    v_cvt_pk_bf16_f32 v81, 0, v81
    v_cvt_pk_bf16_f32 v82, 0, v82
    v_cvt_pk_bf16_f32 v83, 0, v83
    v_pk_mul_f32 v[76:77], v[76:77], s[90:91]
    v_pk_mul_f32 v[78:79], v[78:79], s[90:91]
    v_pk_mul_f32 v[80:81], v[80:81], s[90:91]
    v_pk_mul_f32 v[82:83], v[82:83], s[90:91]
    v_exp_f32 v76, v76
    v_exp_f32 v77, v77
    v_exp_f32 v78, v78
    v_exp_f32 v79, v79
    v_exp_f32 v80, v80
    v_exp_f32 v81, v81
    v_exp_f32 v82, v82
    v_exp_f32 v83, v83
    v_cvt_pk_bf16_f32 v76, v76, v77
    v_cvt_pk_bf16_f32 v77, v78, v79
    v_cvt_pk_bf16_f32 v78, v80, v81
    v_cvt_pk_bf16_f32 v79, v82, v83
    s_nop 0
    v_mfma_f32_4x4x4_16b_bf16 v[44:47], v[116:117], v[76:77], 0
    v_mfma_f32_4x4x4_16b_bf16 v[48:51], v[112:113], v[76:77], 0
    s_nop 0
    v_mfma_f32_4x4x4_16b_bf16 v[44:47], v[118:119], v[78:79], v[44:47]
    v_mfma_f32_4x4x4_16b_bf16 v[48:51], v[114:115], v[78:79], v[48:51]
    v_lshlrev_b32 v96, 16, v98
    v_and_b32 v97, 0xffff0000, v98
    v_lshlrev_b32 v98, 16, v99
    v_and_b32 v99, 0xffff0000, v99
    v_pk_mul_f32 v[44:45], v[44:45], s[92:93]
    v_pk_mul_f32 v[46:47], v[46:47], s[92:93]
    v_cvt_pk_bf16_f32 v48, 0, v48
    v_cvt_pk_bf16_f32 v49, 0, v49
    v_cvt_pk_bf16_f32 v50, 0, v50
    v_cvt_pk_bf16_f32 v51, 0, v51
    s_add_u32 s31, s62, 49152
    s_mov_b32 s14, s63
    buffer_store_dwordx4 v[60:63], v19, s[12:15], s31 offen sc1
    s_add_u32 s31, s60, 65536
    s_mov_b32 s14, s61
    buffer_store_dwordx4 v[64:67], v19, s[12:15], s31 offen sc1
    v_lshlrev_b32 v82, 16, v93
    v_pk_add_f32 v[76:77], v[82:83], s[66:67] op_sel_hi:[0,1] neg_lo:[0,1] neg_hi:[0,1]
    v_pk_add_f32 v[78:79], v[82:83], s[68:69] op_sel_hi:[0,1] neg_lo:[0,1] neg_hi:[0,1]
    v_pk_add_f32 v[80:81], v[82:83], s[70:71] op_sel_hi:[0,1] neg_lo:[0,1] neg_hi:[0,1]
    v_pk_add_f32 v[82:83], v[82:83], s[72:73] op_sel_hi:[0,1] neg_lo:[0,1] neg_hi:[0,1]
    v_cvt_pk_bf16_f32 v76, 0, v76
    v_cvt_pk_bf16_f32 v77, 0, v77
    v_cvt_pk_bf16_f32 v78, 0, v78
    v_cvt_pk_bf16_f32 v79, 0, v79
    v_cvt_pk_bf16_f32 v80, 0, v80
    v_cvt_pk_bf16_f32 v81, 0, v81
    v_cvt_pk_bf16_f32 v82, 0, v82
    v_cvt_pk_bf16_f32 v83, 0, v83
    v_pk_mul_f32 v[76:77], v[76:77], v[76:77]
    v_pk_mul_f32 v[78:79], v[78:79], v[78:79]
    v_pk_mul_f32 v[80:81], v[80:81], v[80:81]
    v_pk_mul_f32 v[82:83], v[82:83], v[82:83]
    v_cvt_pk_bf16_f32 v76, 0, v76
    v_cvt_pk_bf16_f32 v77, 0, v77
    v_cvt_pk_bf16_f32 v78, 0, v78
    v_cvt_pk_bf16_f32 v79, 0, v79
    v_cvt_pk_bf16_f32 v80, 0, v80
    v_cvt_pk_bf16_f32 v81, 0, v81
    v_cvt_pk_bf16_f32 v82, 0, v82
    v_cvt_pk_bf16_f32 v83, 0, v83
    v_pk_mul_f32 v[76:77], v[76:77], s[88:89]
    v_pk_mul_f32 v[78:79], v[78:79], s[88:89]
    v_pk_mul_f32 v[80:81], v[80:81], s[88:89]
    v_pk_mul_f32 v[82:83], v[82:83], s[88:89]
    v_cvt_pk_bf16_f32 v76, 0, v76
    v_cvt_pk_bf16_f32 v77, 0, v77
    v_cvt_pk_bf16_f32 v78, 0, v78
    v_cvt_pk_bf16_f32 v79, 0, v79
    v_cvt_pk_bf16_f32 v80, 0, v80
    v_cvt_pk_bf16_f32 v81, 0, v81
    v_cvt_pk_bf16_f32 v82, 0, v82
    v_cvt_pk_bf16_f32 v83, 0, v83
    v_pk_mul_f32 v[76:77], v[76:77], s[90:91]
    v_pk_mul_f32 v[78:79], v[78:79], s[90:91]
    v_pk_mul_f32 v[80:81], v[80:81], s[90:91]
    v_pk_mul_f32 v[82:83], v[82:83], s[90:91]
    v_exp_f32 v76, v76
    v_exp_f32 v77, v77
    v_exp_f32 v78, v78
    v_exp_f32 v79, v79
    v_exp_f32 v80, v80
    v_exp_f32 v81, v81
    v_exp_f32 v82, v82
    v_exp_f32 v83, v83
    v_cvt_pk_bf16_f32 v76, v76, v77
    v_cvt_pk_bf16_f32 v77, v78, v79
    v_cvt_pk_bf16_f32 v78, v80, v81
    v_cvt_pk_bf16_f32 v79, v82, v83
    s_nop 0
    v_mfma_f32_4x4x4_16b_bf16 v[52:55], v[116:117], v[76:77], 0
    v_mfma_f32_4x4x4_16b_bf16 v[56:59], v[112:113], v[76:77], 0
    s_nop 0
    v_mfma_f32_4x4x4_16b_bf16 v[52:55], v[118:119], v[78:79], v[52:55]
    v_mfma_f32_4x4x4_16b_bf16 v[56:59], v[114:115], v[78:79], v[56:59]
    v_lshlrev_b32 v100, 16, v102
    v_and_b32 v101, 0xffff0000, v102
    v_lshlrev_b32 v102, 16, v103
    v_and_b32 v103, 0xffff0000, v103
    v_pk_mul_f32 v[52:53], v[52:53], s[92:93]
    v_pk_mul_f32 v[54:55], v[54:55], s[92:93]
    v_cvt_pk_bf16_f32 v56, 0, v56
    v_cvt_pk_bf16_f32 v57, 0, v57
    v_cvt_pk_bf16_f32 v58, 0, v58
    v_cvt_pk_bf16_f32 v59, 0, v59
    s_add_u32 s31, s62, 81920
    s_mov_b32 s14, s63
    buffer_store_dwordx4 v[68:71], v19, s[12:15], s31 offen sc1
    s_add_u32 s31, s60, 98304
    s_mov_b32 s14, s61
    buffer_store_dwordx4 v[72:75], v19, s[12:15], s31 offen sc1
    v_lshlrev_b32 v82, 16, v94
    v_pk_add_f32 v[76:77], v[82:83], s[66:67] op_sel_hi:[0,1] neg_lo:[0,1] neg_hi:[0,1]
    v_pk_add_f32 v[78:79], v[82:83], s[68:69] op_sel_hi:[0,1] neg_lo:[0,1] neg_hi:[0,1]
    v_pk_add_f32 v[80:81], v[82:83], s[70:71] op_sel_hi:[0,1] neg_lo:[0,1] neg_hi:[0,1]
    v_pk_add_f32 v[82:83], v[82:83], s[72:73] op_sel_hi:[0,1] neg_lo:[0,1] neg_hi:[0,1]
    v_cvt_pk_bf16_f32 v76, 0, v76
    v_cvt_pk_bf16_f32 v77, 0, v77
    v_cvt_pk_bf16_f32 v78, 0, v78
    v_cvt_pk_bf16_f32 v79, 0, v79
    v_cvt_pk_bf16_f32 v80, 0, v80
    v_cvt_pk_bf16_f32 v81, 0, v81
    v_cvt_pk_bf16_f32 v82, 0, v82
    v_cvt_pk_bf16_f32 v83, 0, v83
    v_pk_mul_f32 v[76:77], v[76:77], v[76:77]
    v_pk_mul_f32 v[78:79], v[78:79], v[78:79]
    v_pk_mul_f32 v[80:81], v[80:81], v[80:81]
    v_pk_mul_f32 v[82:83], v[82:83], v[82:83]
    v_cvt_pk_bf16_f32 v76, 0, v76
    v_cvt_pk_bf16_f32 v77, 0, v77
    v_cvt_pk_bf16_f32 v78, 0, v78
    v_cvt_pk_bf16_f32 v79, 0, v79
    v_cvt_pk_bf16_f32 v80, 0, v80
    v_cvt_pk_bf16_f32 v81, 0, v81
    v_cvt_pk_bf16_f32 v82, 0, v82
    v_cvt_pk_bf16_f32 v83, 0, v83
    v_pk_mul_f32 v[76:77], v[76:77], s[88:89]
    v_pk_mul_f32 v[78:79], v[78:79], s[88:89]
    v_pk_mul_f32 v[80:81], v[80:81], s[88:89]
    v_pk_mul_f32 v[82:83], v[82:83], s[88:89]
    v_cvt_pk_bf16_f32 v76, 0, v76
    v_cvt_pk_bf16_f32 v77, 0, v77
    v_cvt_pk_bf16_f32 v78, 0, v78
    v_cvt_pk_bf16_f32 v79, 0, v79
    v_cvt_pk_bf16_f32 v80, 0, v80
    v_cvt_pk_bf16_f32 v81, 0, v81
    v_cvt_pk_bf16_f32 v82, 0, v82
    v_cvt_pk_bf16_f32 v83, 0, v83
    v_pk_mul_f32 v[76:77], v[76:77], s[90:91]
    v_pk_mul_f32 v[78:79], v[78:79], s[90:91]
    v_pk_mul_f32 v[80:81], v[80:81], s[90:91]
    v_pk_mul_f32 v[82:83], v[82:83], s[90:91]
    v_exp_f32 v76, v76
    v_exp_f32 v77, v77
    v_exp_f32 v78, v78
    v_exp_f32 v79, v79
    v_exp_f32 v80, v80
    v_exp_f32 v81, v81
    v_exp_f32 v82, v82
    v_exp_f32 v83, v83
    v_cvt_pk_bf16_f32 v76, v76, v77
    v_cvt_pk_bf16_f32 v77, v78, v79
    v_cvt_pk_bf16_f32 v78, v80, v81
    v_cvt_pk_bf16_f32 v79, v82, v83
    s_nop 0
    v_mfma_f32_4x4x4_16b_bf16 v[60:63], v[116:117], v[76:77], 0
    v_mfma_f32_4x4x4_16b_bf16 v[64:67], v[112:113], v[76:77], 0
    s_nop 0
    v_mfma_f32_4x4x4_16b_bf16 v[60:63], v[118:119], v[78:79], v[60:63]
    v_mfma_f32_4x4x4_16b_bf16 v[64:67], v[114:115], v[78:79], v[64:67]
    v_lshlrev_b32 v104, 16, v106
    v_and_b32 v105, 0xffff0000, v106
    v_lshlrev_b32 v106, 16, v107
    v_and_b32 v107, 0xffff0000, v107
    v_pk_mul_f32 v[60:61], v[60:61], s[92:93]
    v_pk_mul_f32 v[62:63], v[62:63], s[92:93]
    v_cvt_pk_bf16_f32 v64, 0, v64
    v_cvt_pk_bf16_f32 v65, 0, v65
    v_cvt_pk_bf16_f32 v66, 0, v66
    v_cvt_pk_bf16_f32 v67, 0, v67
    s_cmp_lg_u32 s3, 0
    s_cbranch_scc1 c_rbf30
    v_lshlrev_b32 v82, 16, v95
    v_pk_add_f32 v[76:77], v[82:83], s[66:67] op_sel_hi:[0,1] neg_lo:[0,1] neg_hi:[0,1]
    v_pk_add_f32 v[78:79], v[82:83], s[68:69] op_sel_hi:[0,1] neg_lo:[0,1] neg_hi:[0,1]
    v_pk_add_f32 v[80:81], v[82:83], s[70:71] op_sel_hi:[0,1] neg_lo:[0,1] neg_hi:[0,1]
    v_pk_add_f32 v[82:83], v[82:83], s[72:73] op_sel_hi:[0,1] neg_lo:[0,1] neg_hi:[0,1]
    v_cvt_pk_bf16_f32 v76, 0, v76
    v_cvt_pk_bf16_f32 v77, 0, v77
    v_cvt_pk_bf16_f32 v78, 0, v78
    v_cvt_pk_bf16_f32 v79, 0, v79
    v_cvt_pk_bf16_f32 v80, 0, v80
    v_cvt_pk_bf16_f32 v81, 0, v81
    v_cvt_pk_bf16_f32 v82, 0, v82
    v_cvt_pk_bf16_f32 v83, 0, v83
    v_pk_mul_f32 v[76:77], v[76:77], v[76:77]
    v_pk_mul_f32 v[78:79], v[78:79], v[78:79]
    v_pk_mul_f32 v[80:81], v[80:81], v[80:81]
    v_pk_mul_f32 v[82:83], v[82:83], v[82:83]
    v_cvt_pk_bf16_f32 v76, 0, v76
    v_cvt_pk_bf16_f32 v77, 0, v77
    v_cvt_pk_bf16_f32 v78, 0, v78
    v_cvt_pk_bf16_f32 v79, 0, v79
    v_cvt_pk_bf16_f32 v80, 0, v80
    v_cvt_pk_bf16_f32 v81, 0, v81
    v_cvt_pk_bf16_f32 v82, 0, v82
    v_cvt_pk_bf16_f32 v83, 0, v83
    v_pk_mul_f32 v[76:77], v[76:77], s[88:89]
    v_pk_mul_f32 v[78:79], v[78:79], s[88:89]
    v_pk_mul_f32 v[80:81], v[80:81], s[88:89]
    v_pk_mul_f32 v[82:83], v[82:83], s[88:89]
    v_cvt_pk_bf16_f32 v76, 0, v76
    v_cvt_pk_bf16_f32 v77, 0, v77
    v_cvt_pk_bf16_f32 v78, 0, v78
    v_cvt_pk_bf16_f32 v79, 0, v79
    v_cvt_pk_bf16_f32 v80, 0, v80
    v_cvt_pk_bf16_f32 v81, 0, v81
    v_cvt_pk_bf16_f32 v82, 0, v82
    v_cvt_pk_bf16_f32 v83, 0, v83
    v_pk_mul_f32 v[76:77], v[76:77], s[90:91]
    v_pk_mul_f32 v[78:79], v[78:79], s[90:91]
    v_pk_mul_f32 v[80:81], v[80:81], s[90:91]
    v_pk_mul_f32 v[82:83], v[82:83], s[90:91]
    v_exp_f32 v76, v76
    v_exp_f32 v77, v77
    v_exp_f32 v78, v78
    v_exp_f32 v79, v79
    v_exp_f32 v80, v80
    v_exp_f32 v81, v81
    v_exp_f32 v82, v82
    v_exp_f32 v83, v83
    v_cvt_pk_bf16_f32 v76, v76, v77
    v_cvt_pk_bf16_f32 v77, v78, v79
    v_cvt_pk_bf16_f32 v78, v80, v81
    v_cvt_pk_bf16_f32 v79, v82, v83
    s_nop 0
    v_mfma_f32_4x4x4_16b_bf16 v[68:71], v[116:117], v[76:77], 0
    v_mfma_f32_4x4x4_16b_bf16 v[72:75], v[112:113], v[76:77], 0
    s_nop 0
    v_mfma_f32_4x4x4_16b_bf16 v[68:71], v[118:119], v[78:79], v[68:71]
    v_mfma_f32_4x4x4_16b_bf16 v[72:75], v[114:115], v[78:79], v[72:75]
    v_lshlrev_b32 v108, 16, v110
    v_and_b32 v109, 0xffff0000, v110
    v_lshlrev_b32 v110, 16, v111
    v_and_b32 v111, 0xffff0000, v111
    v_pk_mul_f32 v[68:69], v[68:69], s[92:93]
    v_pk_mul_f32 v[70:71], v[70:71], s[92:93]
    v_cvt_pk_bf16_f32 v72, 0, v72
    v_cvt_pk_bf16_f32 v73, 0, v73
    v_cvt_pk_bf16_f32 v74, 0, v74
    v_cvt_pk_bf16_f32 v75, 0, v75
c_rbf30:
    s_waitcnt vmcnt(0)
    v_mov_b32 v91, 1
    v_mov_b32 v90, 0
    s_mov_b64 exec, 1
    ds_add_rtn_u32 v90, v90, v91 offset:288
    s_mov_b64 exec, -1
    s_waitcnt lgkmcnt(0)
    v_readfirstlane_b32 s95, v90
    s_nop 0
    s_cmp_lg_u32 s95, 15
    s_cbranch_scc1 c_norow7b
    s_mov_b32 s64, 7
    s_and_b32 s31, s64, 3
    s_lshl_b32 s31, s31, 10
    v_add_u32 v76, s31, v5
    v_mov_b32 v80, 0
    ds_read_b128 v[76:79], v76 offset:2560
    ds_read_b32 v80, v80 offset:308
    s_lshl_b32 s31, s64, 18
    s_lshl_b32 s33, s2, 4
    s_add_u32 s31, s31, s33
    s_add_u32 s31, s31, 234881024
    s_or_b32 s32, s65, 0x80000000
    s_waitcnt lgkmcnt(0)
    v_or3_b32 v76, v76, s32, v80
    v_or3_b32 v77, v77, s32, v80
    v_or3_b32 v78, v78, s32, v80
    v_or3_b32 v79, v79, s32, v80
    v_lshlrev_b32 v80, 8, v5
    buffer_store_dwordx4 v[76:79], v80, s[8:11], s31 offen sc1
    s_nop 1
c_norow7b:
c_loopdone:
    s_mov_b64 exec, -1
    v_lshl_add_u32 v11, v0, 4, v8
    s_mov_b32 s74, 1207959552
    s_mov_b32 s75, 1140850688
    s_mov_b32 s76, 1077936128
    s_mov_b32 s77, 1212153856
    s_mov_b32 s78, 1145044992
    v_mov_b32 v12, 0
    s_waitcnt vmcnt(0) lgkmcnt(0)
    s_barrier
    ds_read_b128 v[20:23], v11 offset:0
    ds_read_b128 v[24:27], v11 offset:16384
    ds_read_b128 v[28:31], v11 offset:32768
    s_waitcnt lgkmcnt(2)
    v_lshrrev_b32 v76, 30, v20
    v_mul_lo_u32 v77, v76, s74
    v_sub_u32 v77, v21, v77
    v_lshrrev_b32 v77, 29, v77
    v_lshl_add_u32 v76, v77, 2, v76
    v_mul_lo_u32 v77, v76, s75
    v_sub_u32 v77, v22, v77
    v_lshrrev_b32 v77, 31, v77
    v_lshl_add_u32 v76, v77, 5, v76
    v_add_u32 v12, v12, v76
    v_mul_lo_u32 v77, v76, s76
    v_mul_lo_u32 v78, v76, s77
    v_mul_lo_u32 v79, v76, s78
    v_sub_u32 v20, v20, v77
    v_sub_u32 v21, v21, v78
    v_sub_u32 v22, v22, v79
    v_sub_u32 v23, v23, v77
    v_cvt_f32_i32 v20, v20
    v_cvt_f32_i32 v21, v21
    v_cvt_f32_i32 v22, v22
    v_cvt_f32_i32 v23, v23
    v_cvt_f32_u32 v76, v76
    v_max3_f32 v77, |v20|, |v21|, |v22|
    v_max_f32 v77, |v23|, v77
    v_mul_f32 v36, 0x44800000, v76
    v_cmp_lt_f32_e64 s[66:67], v77, v36
    s_waitcnt lgkmcnt(1)
    v_lshrrev_b32 v76, 30, v24
    v_mul_lo_u32 v77, v76, s74
    v_sub_u32 v77, v25, v77
    v_lshrrev_b32 v77, 29, v77
    v_lshl_add_u32 v76, v77, 2, v76
    v_mul_lo_u32 v77, v76, s75
    v_sub_u32 v77, v26, v77
    v_lshrrev_b32 v77, 31, v77
    v_lshl_add_u32 v76, v77, 5, v76
    v_add_u32 v12, v12, v76
    v_mul_lo_u32 v77, v76, s76
    v_mul_lo_u32 v78, v76, s77
    v_mul_lo_u32 v79, v76, s78
    v_sub_u32 v24, v24, v77
    v_sub_u32 v25, v25, v78
    v_sub_u32 v26, v26, v79
    v_sub_u32 v27, v27, v77
    v_cvt_f32_i32 v24, v24
    v_cvt_f32_i32 v25, v25
    v_cvt_f32_i32 v26, v26
    v_cvt_f32_i32 v27, v27
    v_cvt_f32_u32 v76, v76
    v_max3_f32 v77, |v24|, |v25|, |v26|
    v_max_f32 v77, |v27|, v77
    v_mul_f32 v37, 0x44800000, v76
    v_cmp_lt_f32_e64 s[68:69], v77, v37
    s_waitcnt lgkmcnt(0)
    v_lshrrev_b32 v76, 30, v28
    v_mul_lo_u32 v77, v76, s74
    v_sub_u32 v77, v29, v77
    v_lshrrev_b32 v77, 29, v77
    v_lshl_add_u32 v76, v77, 2, v76
    v_mul_lo_u32 v77, v76, s75
    v_sub_u32 v77, v30, v77
    v_lshrrev_b32 v77, 31, v77
    v_lshl_add_u32 v76, v77, 5, v76
    v_add_u32 v12, v12, v76
    v_mul_lo_u32 v77, v76, s76
    v_mul_lo_u32 v78, v76, s77
    v_mul_lo_u32 v79, v76, s78
    v_sub_u32 v28, v28, v77
    v_sub_u32 v29, v29, v78
    v_sub_u32 v30, v30, v79
    v_sub_u32 v31, v31, v77
    v_cvt_f32_i32 v28, v28
    v_cvt_f32_i32 v29, v29
    v_cvt_f32_i32 v30, v30
    v_cvt_f32_i32 v31, v31
    v_cvt_f32_u32 v76, v76
    v_max3_f32 v77, |v28|, |v29|, |v30|
    v_max_f32 v77, |v31|, v77
    v_mul_f32 v38, 0x44800000, v76
    v_cmp_lt_f32_e64 s[70:71], v77, v38
    v_pk_mul_f32 v[20:21], v[20:21], v[44:45]
    v_pk_mul_f32 v[22:23], v[22:23], v[46:47]
    v_cvt_pk_bf16_f32 v20, v20, v21
    v_cvt_pk_bf16_f32 v21, v22, v23
    v_pk_mul_f32 v[24:25], v[24:25], v[52:53]
    v_pk_mul_f32 v[26:27], v[26:27], v[54:55]
    v_cvt_pk_bf16_f32 v24, v24, v25
    v_cvt_pk_bf16_f32 v25, v26, v27
    v_pk_mul_f32 v[28:29], v[28:29], v[60:61]
    v_pk_mul_f32 v[30:31], v[30:31], v[62:63]
    v_cvt_pk_bf16_f32 v28, v28, v29
    v_cvt_pk_bf16_f32 v29, v30, v31
    s_nop 1
    v_mfma_f32_4x4x4_16b_bf16 v[76:79], v[120:121], v[20:21], 0
    v_mfma_f32_4x4x4_16b_bf16 v[80:83], v[120:121], v[24:25], 0
    v_mfma_f32_4x4x4_16b_bf16 v[84:87], v[120:121], v[28:29], 0
    s_nop 2
    v_cvt_pk_bf16_f32 v76, 0, v76
    v_cvt_pk_bf16_f32 v77, 0, v77
    v_cvt_pk_bf16_f32 v78, 0, v78
    v_cvt_pk_bf16_f32 v79, 0, v79
    v_pk_mul_f32 v[76:77], v[76:77], v[48:49]
    v_pk_mul_f32 v[78:79], v[78:79], v[50:51]
    v_cvt_pk_bf16_f32 v76, 0, v76
    v_cvt_pk_bf16_f32 v77, 0, v77
    v_cvt_pk_bf16_f32 v78, 0, v78
    v_cvt_pk_bf16_f32 v79, 0, v79
    v_pk_add_f32 v[76:77], v[76:77], v[96:97]
    v_pk_add_f32 v[78:79], v[78:79], v[98:99]
    v_cvt_pk_bf16_f32 v20, v76, v77
    v_cvt_pk_bf16_f32 v21, v78, v79
    s_add_u32 s31, s40, 0
    buffer_store_dwordx2 v[20:21], v10, s[24:27], s31 offen sc1
    s_cmp_eq_u64 s[66:67], 0
    s_cbranch_scc1 c_sure0
    v_mul_f32_e64 v88, v36, |v44|
    v_mul_f32_e64 v89, v36, |v45|
    v_mul_f32_e64 v90, v36, |v46|
    v_mul_f32_e64 v91, v36, |v47|
    v_cvt_pk_bf16_f32 v42, v88, v89
    v_cvt_pk_bf16_f32 v43, v90, v91
    v_and_b32 v14, 0x7fff7fff, v120
    v_and_b32 v15, 0x7fff7fff, v121
    s_nop 1
    v_mfma_f32_4x4x4_16b_bf16 v[88:91], v[14:15], v[42:43], 0
    v_max3_f32 v14, |v76|, |v77|, |v78|
    v_max_f32 v14, |v79|, v14
    v_mul_f32 v14, 0x3f800000, v14
    s_nop 1
    v_mul_f32_e64 v88, v88, |v48|
    v_mul_f32_e64 v89, v89, |v49|
    v_mul_f32_e64 v90, v90, |v50|
    v_mul_f32_e64 v91, v91, |v51|
    v_max3_f32 v88, v88, v89, v90
    v_max_f32 v88, v88, v91
    v_cmp_nle_f32 vcc, v88, v14
    s_and_b64 vcc, vcc, s[66:67]
    s_or_b64 s[80:81], s[80:81], vcc
c_sure0:
    v_cvt_pk_bf16_f32 v80, 0, v80
    v_cvt_pk_bf16_f32 v81, 0, v81
    v_cvt_pk_bf16_f32 v82, 0, v82
    v_cvt_pk_bf16_f32 v83, 0, v83
    v_pk_mul_f32 v[80:81], v[80:81], v[56:57]
    v_pk_mul_f32 v[82:83], v[82:83], v[58:59]
    v_cvt_pk_bf16_f32 v80, 0, v80
    v_cvt_pk_bf16_f32 v81, 0, v81
    v_cvt_pk_bf16_f32 v82, 0, v82
    v_cvt_pk_bf16_f32 v83, 0, v83
    v_pk_add_f32 v[80:81], v[80:81], v[100:101]
    v_pk_add_f32 v[82:83], v[82:83], v[102:103]
    v_cvt_pk_bf16_f32 v24, v80, v81
    v_cvt_pk_bf16_f32 v25, v82, v83
    s_add_u32 s31, s40, 2097152
    buffer_store_dwordx2 v[24:25], v10, s[24:27], s31 offen sc1
    s_cmp_eq_u64 s[68:69], 0
    s_cbranch_scc1 c_sure1
    v_mul_f32_e64 v88, v37, |v52|
    v_mul_f32_e64 v89, v37, |v53|
    v_mul_f32_e64 v90, v37, |v54|
    v_mul_f32_e64 v91, v37, |v55|
    v_cvt_pk_bf16_f32 v42, v88, v89
    v_cvt_pk_bf16_f32 v43, v90, v91
    v_and_b32 v14, 0x7fff7fff, v120
    v_and_b32 v15, 0x7fff7fff, v121
    s_nop 1
    v_mfma_f32_4x4x4_16b_bf16 v[88:91], v[14:15], v[42:43], 0
    v_max3_f32 v14, |v80|, |v81|, |v82|
    v_max_f32 v14, |v83|, v14
    v_mul_f32 v14, 0x3f800000, v14
    s_nop 1
    v_mul_f32_e64 v88, v88, |v56|
    v_mul_f32_e64 v89, v89, |v57|
    v_mul_f32_e64 v90, v90, |v58|
    v_mul_f32_e64 v91, v91, |v59|
    v_max3_f32 v88, v88, v89, v90
    v_max_f32 v88, v88, v91
    v_cmp_nle_f32 vcc, v88, v14
    s_and_b64 vcc, vcc, s[68:69]
    s_or_b64 s[80:81], s[80:81], vcc
c_sure1:
    v_cvt_pk_bf16_f32 v84, 0, v84
    v_cvt_pk_bf16_f32 v85, 0, v85
    v_cvt_pk_bf16_f32 v86, 0, v86
    v_cvt_pk_bf16_f32 v87, 0, v87
    v_pk_mul_f32 v[84:85], v[84:85], v[64:65]
    v_pk_mul_f32 v[86:87], v[86:87], v[66:67]
    v_cvt_pk_bf16_f32 v84, 0, v84
    v_cvt_pk_bf16_f32 v85, 0, v85
    v_cvt_pk_bf16_f32 v86, 0, v86
    v_cvt_pk_bf16_f32 v87, 0, v87
    v_pk_add_f32 v[84:85], v[84:85], v[104:105]
    v_pk_add_f32 v[86:87], v[86:87], v[106:107]
    v_cvt_pk_bf16_f32 v28, v84, v85
    v_cvt_pk_bf16_f32 v29, v86, v87
    s_add_u32 s31, s40, 4194304
    buffer_store_dwordx2 v[28:29], v10, s[24:27], s31 offen sc1
    s_cmp_eq_u64 s[70:71], 0
    s_cbranch_scc1 c_sure2
    v_mul_f32_e64 v88, v38, |v60|
    v_mul_f32_e64 v89, v38, |v61|
    v_mul_f32_e64 v90, v38, |v62|
    v_mul_f32_e64 v91, v38, |v63|
    v_cvt_pk_bf16_f32 v42, v88, v89
    v_cvt_pk_bf16_f32 v43, v90, v91
    v_and_b32 v14, 0x7fff7fff, v120
    v_and_b32 v15, 0x7fff7fff, v121
    s_nop 1
    v_mfma_f32_4x4x4_16b_bf16 v[88:91], v[14:15], v[42:43], 0
    v_max3_f32 v14, |v84|, |v85|, |v86|
    v_max_f32 v14, |v87|, v14
    v_mul_f32 v14, 0x3f800000, v14
    s_nop 1
    v_mul_f32_e64 v88, v88, |v64|
    v_mul_f32_e64 v89, v89, |v65|
    v_mul_f32_e64 v90, v90, |v66|
    v_mul_f32_e64 v91, v91, |v67|
    v_max3_f32 v88, v88, v89, v90
    v_max_f32 v88, v88, v91
    v_cmp_nle_f32 vcc, v88, v14
    s_and_b64 vcc, vcc, s[70:71]
    s_or_b64 s[80:81], s[80:81], vcc
c_sure2:
    s_cmp_gt_u32 s3, 2
    s_cbranch_scc1 c_epi3
    ds_read_b128 v[32:35], v11 offset:49152
    s_waitcnt lgkmcnt(0)
    v_lshrrev_b32 v76, 30, v32
    v_mul_lo_u32 v77, v76, s74
    v_sub_u32 v77, v33, v77
    v_lshrrev_b32 v77, 29, v77
    v_lshl_add_u32 v76, v77, 2, v76
    v_mul_lo_u32 v77, v76, s75
    v_sub_u32 v77, v34, v77
    v_lshrrev_b32 v77, 31, v77
    v_lshl_add_u32 v76, v77, 5, v76
    v_add_u32 v12, v12, v76
    s_cmp_lg_u32 s3, 0
    s_cbranch_scc1 c_epi3
    v_mul_lo_u32 v77, v76, s76
    v_mul_lo_u32 v78, v76, s77
    v_mul_lo_u32 v79, v76, s78
    v_sub_u32 v32, v32, v77
    v_sub_u32 v33, v33, v78
    v_sub_u32 v34, v34, v79
    v_sub_u32 v35, v35, v77
    v_cvt_f32_i32 v32, v32
    v_cvt_f32_i32 v33, v33
    v_cvt_f32_i32 v34, v34
    v_cvt_f32_i32 v35, v35
    v_cvt_f32_u32 v76, v76
    v_max3_f32 v77, |v32|, |v33|, |v34|
    v_max_f32 v77, |v35|, v77
    v_mul_f32 v39, 0x44800000, v76
    v_cmp_lt_f32_e64 s[72:73], v77, v39
    v_pk_mul_f32 v[32:33], v[32:33], v[68:69]
    v_pk_mul_f32 v[34:35], v[34:35], v[70:71]
    v_cvt_pk_bf16_f32 v32, v32, v33
    v_cvt_pk_bf16_f32 v33, v34, v35
    s_nop 1
    v_mfma_f32_4x4x4_16b_bf16 v[76:79], v[120:121], v[32:33], 0
    s_nop 4
    v_cvt_pk_bf16_f32 v76, 0, v76
    v_cvt_pk_bf16_f32 v77, 0, v77
    v_cvt_pk_bf16_f32 v78, 0, v78
    v_cvt_pk_bf16_f32 v79, 0, v79
    v_pk_mul_f32 v[76:77], v[76:77], v[72:73]
    v_pk_mul_f32 v[78:79], v[78:79], v[74:75]
    v_cvt_pk_bf16_f32 v76, 0, v76
    v_cvt_pk_bf16_f32 v77, 0, v77
    v_cvt_pk_bf16_f32 v78, 0, v78
    v_cvt_pk_bf16_f32 v79, 0, v79
    v_pk_add_f32 v[76:77], v[76:77], v[108:109]
    v_pk_add_f32 v[78:79], v[78:79], v[110:111]
    v_cvt_pk_bf16_f32 v32, v76, v77
    v_cvt_pk_bf16_f32 v33, v78, v79
    s_add_u32 s31, s40, 6291456
    buffer_store_dwordx2 v[32:33], v10, s[24:27], s31 offen sc1
    s_cmp_eq_u64 s[72:73], 0
    s_cbranch_scc1 c_sure3
    v_mul_f32_e64 v88, v39, |v68|
    v_mul_f32_e64 v89, v39, |v69|
    v_mul_f32_e64 v90, v39, |v70|
    v_mul_f32_e64 v91, v39, |v71|
    v_cvt_pk_bf16_f32 v42, v88, v89
    v_cvt_pk_bf16_f32 v43, v90, v91
    v_and_b32 v14, 0x7fff7fff, v120
    v_and_b32 v15, 0x7fff7fff, v121
    s_nop 1
    v_mfma_f32_4x4x4_16b_bf16 v[88:91], v[14:15], v[42:43], 0
    v_max3_f32 v14, |v76|, |v77|, |v78|
    v_max_f32 v14, |v79|, v14
    v_mul_f32 v14, 0x3f800000, v14
    s_nop 1
    v_mul_f32_e64 v88, v88, |v72|
    v_mul_f32_e64 v89, v89, |v73|
    v_mul_f32_e64 v90, v90, |v74|
    v_mul_f32_e64 v91, v91, |v75|
    v_max3_f32 v88, v88, v89, v90
    v_max_f32 v88, v88, v91
    v_cmp_nle_f32 vcc, v88, v14
    s_and_b64 vcc, vcc, s[72:73]
    s_or_b64 s[80:81], s[80:81], vcc
c_sure3:
c_epi3:
    s_nop 1
    v_add_u32_dpp v12, v12, v12 row_shr:1 row_mask:0xf bank_mask:0xf
    s_nop 1
    v_add_u32_dpp v12, v12, v12 row_shr:2 row_mask:0xf bank_mask:0xf
    s_nop 1
    v_add_u32_dpp v12, v12, v12 row_shr:4 row_mask:0xf bank_mask:0xf
    s_nop 1
    v_add_u32_dpp v12, v12, v12 row_shr:8 row_mask:0xf bank_mask:0xf
    s_nop 1
    v_add_u32_dpp v12, v12, v12 row_bcast:15 row_mask:0xa bank_mask:0xf
    s_nop 1
    v_add_u32_dpp v12, v12, v12 row_bcast:31 row_mask:0xc bank_mask:0xf
    s_cmp_eq_u64 s[80:81], 0
    s_cselect_b32 s31, 0, 0x1000000
    s_lshl_b32 s32, s53, 1
    s_sub_u32 s31, s31, s32
    v_mov_b32 v76, 0
    v_add_u32 v12, s31, v12
    s_bfm_b64 exec, 1, 63
    ds_add_u32 v76, v12 offset:304
    s_mov_b64 exec, -1
    s_waitcnt lgkmcnt(0)
    s_barrier
    ds_read_b32 v76, v76 offset:304
    s_waitcnt lgkmcnt(0)
    v_readfirstlane_b32 s31, v76
    s_nop 0
    s_cmp_eq_u32 s31, 0
    s_cbranch_scc1 f_done
c_fallback:
    v_lshlrev_b32 v79, 2, v3
    ds_read_b32 v79, v79 offset:256
    s_waitcnt lgkmcnt(0)
    v_readlane_b32 s66, v79, 0
    v_readlane_b32 s67, v79, 1
    v_readlane_b32 s68, v79, 2
    v_readlane_b32 s69, v79, 3
    v_readlane_b32 s70, v79, 4
    v_readlane_b32 s71, v79, 5
    v_readlane_b32 s72, v79, 6
    v_readlane_b32 s73, v79, 7
    v_lshlrev_b32 v82, 16, v92
    v_pk_add_f32 v[76:77], v[82:83], s[66:67] op_sel_hi:[0,1] neg_lo:[0,1] neg_hi:[0,1]
    v_pk_add_f32 v[78:79], v[82:83], s[68:69] op_sel_hi:[0,1] neg_lo:[0,1] neg_hi:[0,1]
    v_pk_add_f32 v[80:81], v[82:83], s[70:71] op_sel_hi:[0,1] neg_lo:[0,1] neg_hi:[0,1]
    v_pk_add_f32 v[82:83], v[82:83], s[72:73] op_sel_hi:[0,1] neg_lo:[0,1] neg_hi:[0,1]
    v_cvt_pk_bf16_f32 v76, 0, v76
    v_cvt_pk_bf16_f32 v77, 0, v77
    v_cvt_pk_bf16_f32 v78, 0, v78
    v_cvt_pk_bf16_f32 v79, 0, v79
    v_cvt_pk_bf16_f32 v80, 0, v80
    v_cvt_pk_bf16_f32 v81, 0, v81
    v_cvt_pk_bf16_f32 v82, 0, v82
    v_cvt_pk_bf16_f32 v83, 0, v83
    v_pk_mul_f32 v[76:77], v[76:77], v[76:77]
    v_pk_mul_f32 v[78:79], v[78:79], v[78:79]
    v_pk_mul_f32 v[80:81], v[80:81], v[80:81]
    v_pk_mul_f32 v[82:83], v[82:83], v[82:83]
    v_cvt_pk_bf16_f32 v76, 0, v76
    v_cvt_pk_bf16_f32 v77, 0, v77
    v_cvt_pk_bf16_f32 v78, 0, v78
    v_cvt_pk_bf16_f32 v79, 0, v79
    v_cvt_pk_bf16_f32 v80, 0, v80
    v_cvt_pk_bf16_f32 v81, 0, v81
    v_cvt_pk_bf16_f32 v82, 0, v82
    v_cvt_pk_bf16_f32 v83, 0, v83
    v_pk_mul_f32 v[76:77], v[76:77], s[88:89]
    v_pk_mul_f32 v[78:79], v[78:79], s[88:89]
    v_pk_mul_f32 v[80:81], v[80:81], s[88:89]
    v_pk_mul_f32 v[82:83], v[82:83], s[88:89]
    v_cvt_pk_bf16_f32 v76, 0, v76
    v_cvt_pk_bf16_f32 v77, 0, v77
    v_cvt_pk_bf16_f32 v78, 0, v78
    v_cvt_pk_bf16_f32 v79, 0, v79
    v_cvt_pk_bf16_f32 v80, 0, v80
    v_cvt_pk_bf16_f32 v81, 0, v81
    v_cvt_pk_bf16_f32 v82, 0, v82
    v_cvt_pk_bf16_f32 v83, 0, v83
    v_pk_mul_f32 v[76:77], v[76:77], s[90:91]
    v_pk_mul_f32 v[78:79], v[78:79], s[90:91]
    v_pk_mul_f32 v[80:81], v[80:81], s[90:91]
    v_pk_mul_f32 v[82:83], v[82:83], s[90:91]
    v_exp_f32 v76, v76
    v_exp_f32 v77, v77
    v_exp_f32 v78, v78
    v_exp_f32 v79, v79
    v_exp_f32 v80, v80
    v_exp_f32 v81, v81
    v_exp_f32 v82, v82
    v_exp_f32 v83, v83
    v_cvt_pk_bf16_f32 v76, v76, v77
    v_cvt_pk_bf16_f32 v77, v78, v79
    v_cvt_pk_bf16_f32 v78, v80, v81
    v_cvt_pk_bf16_f32 v79, v82, v83
    s_nop 0
    v_mfma_f32_4x4x4_16b_bf16 v[44:47], v[116:117], v[76:77], 0
    v_mfma_f32_4x4x4_16b_bf16 v[48:51], v[112:113], v[76:77], 0
    s_nop 0
    v_mfma_f32_4x4x4_16b_bf16 v[44:47], v[118:119], v[78:79], v[44:47]
    v_mfma_f32_4x4x4_16b_bf16 v[48:51], v[114:115], v[78:79], v[48:51]
    s_nop 4
    v_cvt_pk_bf16_f32 v48, 0, v48
    v_cvt_pk_bf16_f32 v49, 0, v49
    v_cvt_pk_bf16_f32 v50, 0, v50
    v_cvt_pk_bf16_f32 v51, 0, v51
    v_lshlrev_b32 v82, 16, v93
    v_pk_add_f32 v[76:77], v[82:83], s[66:67] op_sel_hi:[0,1] neg_lo:[0,1] neg_hi:[0,1]
    v_pk_add_f32 v[78:79], v[82:83], s[68:69] op_sel_hi:[0,1] neg_lo:[0,1] neg_hi:[0,1]
    v_pk_add_f32 v[80:81], v[82:83], s[70:71] op_sel_hi:[0,1] neg_lo:[0,1] neg_hi:[0,1]
    v_pk_add_f32 v[82:83], v[82:83], s[72:73] op_sel_hi:[0,1] neg_lo:[0,1] neg_hi:[0,1]
    v_cvt_pk_bf16_f32 v76, 0, v76
    v_cvt_pk_bf16_f32 v77, 0, v77
    v_cvt_pk_bf16_f32 v78, 0, v78
    v_cvt_pk_bf16_f32 v79, 0, v79
    v_cvt_pk_bf16_f32 v80, 0, v80
    v_cvt_pk_bf16_f32 v81, 0, v81
    v_cvt_pk_bf16_f32 v82, 0, v82
    v_cvt_pk_bf16_f32 v83, 0, v83
    v_pk_mul_f32 v[76:77], v[76:77], v[76:77]
    v_pk_mul_f32 v[78:79], v[78:79], v[78:79]
    v_pk_mul_f32 v[80:81], v[80:81], v[80:81]
    v_pk_mul_f32 v[82:83], v[82:83], v[82:83]
    v_cvt_pk_bf16_f32 v76, 0, v76
    v_cvt_pk_bf16_f32 v77, 0, v77
    v_cvt_pk_bf16_f32 v78, 0, v78
    v_cvt_pk_bf16_f32 v79, 0, v79
    v_cvt_pk_bf16_f32 v80, 0, v80
    v_cvt_pk_bf16_f32 v81, 0, v81
    v_cvt_pk_bf16_f32 v82, 0, v82
    v_cvt_pk_bf16_f32 v83, 0, v83
    v_pk_mul_f32 v[76:77], v[76:77], s[88:89]
    v_pk_mul_f32 v[78:79], v[78:79], s[88:89]
    v_pk_mul_f32 v[80:81], v[80:81], s[88:89]
    v_pk_mul_f32 v[82:83], v[82:83], s[88:89]
    v_cvt_pk_bf16_f32 v76, 0, v76
    v_cvt_pk_bf16_f32 v77, 0, v77
    v_cvt_pk_bf16_f32 v78, 0, v78
    v_cvt_pk_bf16_f32 v79, 0, v79
    v_cvt_pk_bf16_f32 v80, 0, v80
    v_cvt_pk_bf16_f32 v81, 0, v81
    v_cvt_pk_bf16_f32 v82, 0, v82
    v_cvt_pk_bf16_f32 v83, 0, v83
    v_pk_mul_f32 v[76:77], v[76:77], s[90:91]
    v_pk_mul_f32 v[78:79], v[78:79], s[90:91]
    v_pk_mul_f32 v[80:81], v[80:81], s[90:91]
    v_pk_mul_f32 v[82:83], v[82:83], s[90:91]
    v_exp_f32 v76, v76
    v_exp_f32 v77, v77
    v_exp_f32 v78, v78
    v_exp_f32 v79, v79
    v_exp_f32 v80, v80
    v_exp_f32 v81, v81
    v_exp_f32 v82, v82
    v_exp_f32 v83, v83
    v_cvt_pk_bf16_f32 v76, v76, v77
    v_cvt_pk_bf16_f32 v77, v78, v79
    v_cvt_pk_bf16_f32 v78, v80, v81
    v_cvt_pk_bf16_f32 v79, v82, v83
    s_nop 0
    v_mfma_f32_4x4x4_16b_bf16 v[52:55], v[116:117], v[76:77], 0
    v_mfma_f32_4x4x4_16b_bf16 v[56:59], v[112:113], v[76:77], 0
    s_nop 0
    v_mfma_f32_4x4x4_16b_bf16 v[52:55], v[118:119], v[78:79], v[52:55]
    v_mfma_f32_4x4x4_16b_bf16 v[56:59], v[114:115], v[78:79], v[56:59]
    s_nop 4
    v_cvt_pk_bf16_f32 v56, 0, v56
    v_cvt_pk_bf16_f32 v57, 0, v57
    v_cvt_pk_bf16_f32 v58, 0, v58
    v_cvt_pk_bf16_f32 v59, 0, v59
    v_lshlrev_b32 v82, 16, v94
    v_pk_add_f32 v[76:77], v[82:83], s[66:67] op_sel_hi:[0,1] neg_lo:[0,1] neg_hi:[0,1]
    v_pk_add_f32 v[78:79], v[82:83], s[68:69] op_sel_hi:[0,1] neg_lo:[0,1] neg_hi:[0,1]
    v_pk_add_f32 v[80:81], v[82:83], s[70:71] op_sel_hi:[0,1] neg_lo:[0,1] neg_hi:[0,1]
    v_pk_add_f32 v[82:83], v[82:83], s[72:73] op_sel_hi:[0,1] neg_lo:[0,1] neg_hi:[0,1]
    v_cvt_pk_bf16_f32 v76, 0, v76
    v_cvt_pk_bf16_f32 v77, 0, v77
    v_cvt_pk_bf16_f32 v78, 0, v78
    v_cvt_pk_bf16_f32 v79, 0, v79
    v_cvt_pk_bf16_f32 v80, 0, v80
    v_cvt_pk_bf16_f32 v81, 0, v81
    v_cvt_pk_bf16_f32 v82, 0, v82
    v_cvt_pk_bf16_f32 v83, 0, v83
    v_pk_mul_f32 v[76:77], v[76:77], v[76:77]
    v_pk_mul_f32 v[78:79], v[78:79], v[78:79]
    v_pk_mul_f32 v[80:81], v[80:81], v[80:81]
    v_pk_mul_f32 v[82:83], v[82:83], v[82:83]
    v_cvt_pk_bf16_f32 v76, 0, v76
    v_cvt_pk_bf16_f32 v77, 0, v77
    v_cvt_pk_bf16_f32 v78, 0, v78
    v_cvt_pk_bf16_f32 v79, 0, v79
    v_cvt_pk_bf16_f32 v80, 0, v80
    v_cvt_pk_bf16_f32 v81, 0, v81
    v_cvt_pk_bf16_f32 v82, 0, v82
    v_cvt_pk_bf16_f32 v83, 0, v83
    v_pk_mul_f32 v[76:77], v[76:77], s[88:89]
    v_pk_mul_f32 v[78:79], v[78:79], s[88:89]
    v_pk_mul_f32 v[80:81], v[80:81], s[88:89]
    v_pk_mul_f32 v[82:83], v[82:83], s[88:89]
    v_cvt_pk_bf16_f32 v76, 0, v76
    v_cvt_pk_bf16_f32 v77, 0, v77
    v_cvt_pk_bf16_f32 v78, 0, v78
    v_cvt_pk_bf16_f32 v79, 0, v79
    v_cvt_pk_bf16_f32 v80, 0, v80
    v_cvt_pk_bf16_f32 v81, 0, v81
    v_cvt_pk_bf16_f32 v82, 0, v82
    v_cvt_pk_bf16_f32 v83, 0, v83
    v_pk_mul_f32 v[76:77], v[76:77], s[90:91]
    v_pk_mul_f32 v[78:79], v[78:79], s[90:91]
    v_pk_mul_f32 v[80:81], v[80:81], s[90:91]
    v_pk_mul_f32 v[82:83], v[82:83], s[90:91]
    v_exp_f32 v76, v76
    v_exp_f32 v77, v77
    v_exp_f32 v78, v78
    v_exp_f32 v79, v79
    v_exp_f32 v80, v80
    v_exp_f32 v81, v81
    v_exp_f32 v82, v82
    v_exp_f32 v83, v83
    v_cvt_pk_bf16_f32 v76, v76, v77
    v_cvt_pk_bf16_f32 v77, v78, v79
    v_cvt_pk_bf16_f32 v78, v80, v81
    v_cvt_pk_bf16_f32 v79, v82, v83
    s_nop 0
    v_mfma_f32_4x4x4_16b_bf16 v[60:63], v[116:117], v[76:77], 0
    v_mfma_f32_4x4x4_16b_bf16 v[64:67], v[112:113], v[76:77], 0
    s_nop 0
    v_mfma_f32_4x4x4_16b_bf16 v[60:63], v[118:119], v[78:79], v[60:63]
    v_mfma_f32_4x4x4_16b_bf16 v[64:67], v[114:115], v[78:79], v[64:67]
    s_nop 4
    v_cvt_pk_bf16_f32 v64, 0, v64
    v_cvt_pk_bf16_f32 v65, 0, v65
    v_cvt_pk_bf16_f32 v66, 0, v66
    v_cvt_pk_bf16_f32 v67, 0, v67
    s_cmp_lg_u32 s3, 0
    s_cbranch_scc1 c_rbf3f
    v_lshlrev_b32 v82, 16, v95
    v_pk_add_f32 v[76:77], v[82:83], s[66:67] op_sel_hi:[0,1] neg_lo:[0,1] neg_hi:[0,1]
    v_pk_add_f32 v[78:79], v[82:83], s[68:69] op_sel_hi:[0,1] neg_lo:[0,1] neg_hi:[0,1]
    v_pk_add_f32 v[80:81], v[82:83], s[70:71] op_sel_hi:[0,1] neg_lo:[0,1] neg_hi:[0,1]
    v_pk_add_f32 v[82:83], v[82:83], s[72:73] op_sel_hi:[0,1] neg_lo:[0,1] neg_hi:[0,1]
    v_cvt_pk_bf16_f32 v76, 0, v76
    v_cvt_pk_bf16_f32 v77, 0, v77
    v_cvt_pk_bf16_f32 v78, 0, v78
    v_cvt_pk_bf16_f32 v79, 0, v79
    v_cvt_pk_bf16_f32 v80, 0, v80
    v_cvt_pk_bf16_f32 v81, 0, v81
    v_cvt_pk_bf16_f32 v82, 0, v82
    v_cvt_pk_bf16_f32 v83, 0, v83
    v_pk_mul_f32 v[76:77], v[76:77], v[76:77]
    v_pk_mul_f32 v[78:79], v[78:79], v[78:79]
    v_pk_mul_f32 v[80:81], v[80:81], v[80:81]
    v_pk_mul_f32 v[82:83], v[82:83], v[82:83]
    v_cvt_pk_bf16_f32 v76, 0, v76
    v_cvt_pk_bf16_f32 v77, 0, v77
    v_cvt_pk_bf16_f32 v78, 0, v78
    v_cvt_pk_bf16_f32 v79, 0, v79
    v_cvt_pk_bf16_f32 v80, 0, v80
    v_cvt_pk_bf16_f32 v81, 0, v81
    v_cvt_pk_bf16_f32 v82, 0, v82
    v_cvt_pk_bf16_f32 v83, 0, v83
    v_pk_mul_f32 v[76:77], v[76:77], s[88:89]
    v_pk_mul_f32 v[78:79], v[78:79], s[88:89]
    v_pk_mul_f32 v[80:81], v[80:81], s[88:89]
    v_pk_mul_f32 v[82:83], v[82:83], s[88:89]
    v_cvt_pk_bf16_f32 v76, 0, v76
    v_cvt_pk_bf16_f32 v77, 0, v77
    v_cvt_pk_bf16_f32 v78, 0, v78
    v_cvt_pk_bf16_f32 v79, 0, v79
    v_cvt_pk_bf16_f32 v80, 0, v80
    v_cvt_pk_bf16_f32 v81, 0, v81
    v_cvt_pk_bf16_f32 v82, 0, v82
    v_cvt_pk_bf16_f32 v83, 0, v83
    v_pk_mul_f32 v[76:77], v[76:77], s[90:91]
    v_pk_mul_f32 v[78:79], v[78:79], s[90:91]
    v_pk_mul_f32 v[80:81], v[80:81], s[90:91]
    v_pk_mul_f32 v[82:83], v[82:83], s[90:91]
    v_exp_f32 v76, v76
    v_exp_f32 v77, v77
    v_exp_f32 v78, v78
    v_exp_f32 v79, v79
    v_exp_f32 v80, v80
    v_exp_f32 v81, v81
    v_exp_f32 v82, v82
    v_exp_f32 v83, v83
    v_cvt_pk_bf16_f32 v76, v76, v77
    v_cvt_pk_bf16_f32 v77, v78, v79
    v_cvt_pk_bf16_f32 v78, v80, v81
    v_cvt_pk_bf16_f32 v79, v82, v83
    s_nop 0
    v_mfma_f32_4x4x4_16b_bf16 v[68:71], v[116:117], v[76:77], 0
    v_mfma_f32_4x4x4_16b_bf16 v[72:75], v[112:113], v[76:77], 0
    s_nop 0
    v_mfma_f32_4x4x4_16b_bf16 v[68:71], v[118:119], v[78:79], v[68:71]
    v_mfma_f32_4x4x4_16b_bf16 v[72:75], v[114:115], v[78:79], v[72:75]
    s_nop 4
    v_cvt_pk_bf16_f32 v72, 0, v72
    v_cvt_pk_bf16_f32 v73, 0, v73
    v_cvt_pk_bf16_f32 v74, 0, v74
    v_cvt_pk_bf16_f32 v75, 0, v75
c_rbf3f:
    s_load_dwordx2 s[8:9], s[0:1], 8
    s_load_dwordx2 s[12:13], s[0:1], 16
    s_load_dwordx2 s[20:21], s[0:1], 32
    s_load_dwordx2 s[4:5], s[0:1], 48
    s_load_dwordx2 s[6:7], s[0:1], 72
    s_waitcnt vmcnt(0) lgkmcnt(0)
    s_load_dword s33, s[4:5], 0
    s_load_dwordx8 s[52:59], s[6:7], 0
    s_mov_b32 s10, 51200000
    s_mov_b32 s11, 0x00020000
    s_mov_b32 s14, 51200000
    s_mov_b32 s15, 0x00020000
    s_mov_b32 s22, 25600000
    s_mov_b32 s23, 0x00020000
    v_mov_b32 v20, 0
    v_mov_b32 v21, 0
    v_mov_b32 v22, 0
    v_mov_b32 v23, 0
    v_add_u32 v76, 0xc000, v16
    ds_write_b128 v16, v[20:23] offset:512
    ds_write_b128 v16, v[20:23] offset:16896
    ds_write_b128 v16, v[20:23] offset:33280
    ds_write_b128 v76, v[20:23] offset:512
    ds_write_b128 v76, v[20:23] offset:16896
    ds_write_b128 v76, v[20:23] offset:33280
    v_cmpx_gt_u32 vcc, 256, v0
    ds_write_b128 v76, v[20:23] offset:49664
    s_mov_b64 exec, -1
    s_waitcnt lgkmcnt(0)
    s_barrier
    s_lshl_b32 s33, s33, 16
    s_lshl_b32 s64, s52, 16
    s_and_b32 s65, s52, 0xffff0000
    s_lshl_b32 s66, s53, 16
    s_and_b32 s67, s53, 0xffff0000
    s_lshl_b32 s68, s54, 16
    s_and_b32 s69, s54, 0xffff0000
    s_lshl_b32 s70, s55, 16
    s_and_b32 s71, s55, 0xffff0000
    s_lshl_b32 s72, s56, 16
    s_and_b32 s73, s56, 0xffff0000
    s_lshl_b32 s74, s57, 16
    s_and_b32 s75, s57, 0xffff0000
    s_lshl_b32 s76, s58, 16
    s_and_b32 s77, s58, 0xffff0000
    s_lshl_b32 s78, s59, 16
    s_and_b32 s79, s59, 0xffff0000
    s_mov_b32 s30, 0
    v_lshrrev_b32 v12, 1, v16
c_fbloop:
    buffer_load_dwordx4 v[20:23], v16, s[12:15], s30 offen
    s_lshr_b32 s29, s30, 1
    s_waitcnt vmcnt(0)
    v_bfe_u32 v76, v20, 6, 8
    v_cmpx_eq_u32 vcc, s35, v76
    s_cbranch_execz c_fbskip0
    buffer_load_dword v76, v16, s[8:11], s30 offen offset:0
    buffer_load_ushort v32, v12, s[20:23], s29 offen offset:0
    s_waitcnt vmcnt(1)
    v_lshlrev_b32 v76, 3, v76
    buffer_load_dwordx2 v[80:81], v76, s[16:19], 0 offen
    s_waitcnt vmcnt(1)
    v_lshlrev_b32 v32, 16, v32
    v_mul_f32 v32, s33, v32
    v_cvt_pk_bf16_f32 v32, 0, v32
    v_mul_f32 v33, 0x3e22f900, v32
    v_fract_f32 v33, v33
    v_fmamk_f32 v32, v32, 0x36036e4e, v33
    v_cos_f32 v32, v32
    v_lshrrev_b32 v33, 8, v20
    v_cvt_pk_bf16_f32 v32, 0, v32
    v_bfi_b32 v33, 63, v20, v33
    v_lshlrev_b32 v33, 3, v33
    v_add_u32 v34, 51200, v33
    s_waitcnt vmcnt(0)
    v_lshlrev_b32 v76, 16, v80
    v_and_b32 v77, 0xffff0000, v80
    v_lshlrev_b32 v78, 16, v81
    v_and_b32 v79, 0xffff0000, v81
    v_pk_mul_f32 v[80:81], v[76:77], s[64:65] op_sel:[0,0] op_sel_hi:[0,1]
    v_pk_fma_f32 v[80:81], v[76:77], s[68:69], v[80:81] op_sel:[1,0,0] op_sel_hi:[1,1,1]
    v_pk_fma_f32 v[80:81], v[78:79], s[72:73], v[80:81] op_sel:[0,0,0] op_sel_hi:[0,1,1]
    v_pk_fma_f32 v[80:81], v[78:79], s[76:77], v[80:81] op_sel:[1,0,0] op_sel_hi:[1,1,1]
    v_pk_mul_f32 v[82:83], v[76:77], s[66:67] op_sel:[0,0] op_sel_hi:[0,1]
    v_pk_fma_f32 v[82:83], v[76:77], s[70:71], v[82:83] op_sel:[1,0,0] op_sel_hi:[1,1,1]
    v_pk_fma_f32 v[82:83], v[78:79], s[74:75], v[82:83] op_sel:[0,0,0] op_sel_hi:[0,1,1]
    v_pk_fma_f32 v[82:83], v[78:79], s[78:79], v[82:83] op_sel:[1,0,0] op_sel_hi:[1,1,1]
    v_cvt_pk_bf16_f32 v80, 0, v80
    v_cvt_pk_bf16_f32 v81, 0, v81
    v_cvt_pk_bf16_f32 v82, 0, v82
    v_cvt_pk_bf16_f32 v83, 0, v83
    v_mul_f32 v80, v32, v80
    v_cvt_f64_f32 v[84:85], v80
    v_mul_f32 v81, v32, v81
    v_cvt_f64_f32 v[86:87], v81
    v_mul_f32 v82, v32, v82
    v_cvt_f64_f32 v[88:89], v82
    v_mul_f32 v83, v32, v83
    v_cvt_f64_f32 v[90:91], v83
    ds_add_f64 v33, v[84:85] offset:512
    ds_add_f64 v33, v[86:87] offset:26112
    ds_add_f64 v34, v[88:89] offset:512
    ds_add_f64 v34, v[90:91] offset:26112
c_fbskip0:
    s_mov_b64 exec, -1
    v_bfe_u32 v76, v21, 6, 8
    v_cmpx_eq_u32 vcc, s35, v76
    s_cbranch_execz c_fbskip1
    buffer_load_dword v76, v16, s[8:11], s30 offen offset:4
    buffer_load_ushort v32, v12, s[20:23], s29 offen offset:2
    s_waitcnt vmcnt(1)
    v_lshlrev_b32 v76, 3, v76
    buffer_load_dwordx2 v[80:81], v76, s[16:19], 0 offen
    s_waitcnt vmcnt(1)
    v_lshlrev_b32 v32, 16, v32
    v_mul_f32 v32, s33, v32
    v_cvt_pk_bf16_f32 v32, 0, v32
    v_mul_f32 v33, 0x3e22f900, v32
    v_fract_f32 v33, v33
    v_fmamk_f32 v32, v32, 0x36036e4e, v33
    v_cos_f32 v32, v32
    v_lshrrev_b32 v33, 8, v21
    v_cvt_pk_bf16_f32 v32, 0, v32
    v_bfi_b32 v33, 63, v21, v33
    v_lshlrev_b32 v33, 3, v33
    v_add_u32 v34, 51200, v33
    s_waitcnt vmcnt(0)
    v_lshlrev_b32 v76, 16, v80
    v_and_b32 v77, 0xffff0000, v80
    v_lshlrev_b32 v78, 16, v81
    v_and_b32 v79, 0xffff0000, v81
    v_pk_mul_f32 v[80:81], v[76:77], s[64:65] op_sel:[0,0] op_sel_hi:[0,1]
    v_pk_fma_f32 v[80:81], v[76:77], s[68:69], v[80:81] op_sel:[1,0,0] op_sel_hi:[1,1,1]
    v_pk_fma_f32 v[80:81], v[78:79], s[72:73], v[80:81] op_sel:[0,0,0] op_sel_hi:[0,1,1]
    v_pk_fma_f32 v[80:81], v[78:79], s[76:77], v[80:81] op_sel:[1,0,0] op_sel_hi:[1,1,1]
    v_pk_mul_f32 v[82:83], v[76:77], s[66:67] op_sel:[0,0] op_sel_hi:[0,1]
    v_pk_fma_f32 v[82:83], v[76:77], s[70:71], v[82:83] op_sel:[1,0,0] op_sel_hi:[1,1,1]
    v_pk_fma_f32 v[82:83], v[78:79], s[74:75], v[82:83] op_sel:[0,0,0] op_sel_hi:[0,1,1]
    v_pk_fma_f32 v[82:83], v[78:79], s[78:79], v[82:83] op_sel:[1,0,0] op_sel_hi:[1,1,1]
    v_cvt_pk_bf16_f32 v80, 0, v80
    v_cvt_pk_bf16_f32 v81, 0, v81
    v_cvt_pk_bf16_f32 v82, 0, v82
    v_cvt_pk_bf16_f32 v83, 0, v83
    v_mul_f32 v80, v32, v80
    v_cvt_f64_f32 v[84:85], v80
    v_mul_f32 v81, v32, v81
    v_cvt_f64_f32 v[86:87], v81
    v_mul_f32 v82, v32, v82
    v_cvt_f64_f32 v[88:89], v82
    v_mul_f32 v83, v32, v83
    v_cvt_f64_f32 v[90:91], v83
    ds_add_f64 v33, v[84:85] offset:512
    ds_add_f64 v33, v[86:87] offset:26112
    ds_add_f64 v34, v[88:89] offset:512
    ds_add_f64 v34, v[90:91] offset:26112
c_fbskip1:
    s_mov_b64 exec, -1
    v_bfe_u32 v76, v22, 6, 8
    v_cmpx_eq_u32 vcc, s35, v76
    s_cbranch_execz c_fbskip2
    buffer_load_dword v76, v16, s[8:11], s30 offen offset:8
    buffer_load_ushort v32, v12, s[20:23], s29 offen offset:4
    s_waitcnt vmcnt(1)
    v_lshlrev_b32 v76, 3, v76
    buffer_load_dwordx2 v[80:81], v76, s[16:19], 0 offen
    s_waitcnt vmcnt(1)
    v_lshlrev_b32 v32, 16, v32
    v_mul_f32 v32, s33, v32
    v_cvt_pk_bf16_f32 v32, 0, v32
    v_mul_f32 v33, 0x3e22f900, v32
    v_fract_f32 v33, v33
    v_fmamk_f32 v32, v32, 0x36036e4e, v33
    v_cos_f32 v32, v32
    v_lshrrev_b32 v33, 8, v22
    v_cvt_pk_bf16_f32 v32, 0, v32
    v_bfi_b32 v33, 63, v22, v33
    v_lshlrev_b32 v33, 3, v33
    v_add_u32 v34, 51200, v33
    s_waitcnt vmcnt(0)
    v_lshlrev_b32 v76, 16, v80
    v_and_b32 v77, 0xffff0000, v80
    v_lshlrev_b32 v78, 16, v81
    v_and_b32 v79, 0xffff0000, v81
    v_pk_mul_f32 v[80:81], v[76:77], s[64:65] op_sel:[0,0] op_sel_hi:[0,1]
    v_pk_fma_f32 v[80:81], v[76:77], s[68:69], v[80:81] op_sel:[1,0,0] op_sel_hi:[1,1,1]
    v_pk_fma_f32 v[80:81], v[78:79], s[72:73], v[80:81] op_sel:[0,0,0] op_sel_hi:[0,1,1]
    v_pk_fma_f32 v[80:81], v[78:79], s[76:77], v[80:81] op_sel:[1,0,0] op_sel_hi:[1,1,1]
    v_pk_mul_f32 v[82:83], v[76:77], s[66:67] op_sel:[0,0] op_sel_hi:[0,1]
    v_pk_fma_f32 v[82:83], v[76:77], s[70:71], v[82:83] op_sel:[1,0,0] op_sel_hi:[1,1,1]
    v_pk_fma_f32 v[82:83], v[78:79], s[74:75], v[82:83] op_sel:[0,0,0] op_sel_hi:[0,1,1]
    v_pk_fma_f32 v[82:83], v[78:79], s[78:79], v[82:83] op_sel:[1,0,0] op_sel_hi:[1,1,1]
    v_cvt_pk_bf16_f32 v80, 0, v80
    v_cvt_pk_bf16_f32 v81, 0, v81
    v_cvt_pk_bf16_f32 v82, 0, v82
    v_cvt_pk_bf16_f32 v83, 0, v83
    v_mul_f32 v80, v32, v80
    v_cvt_f64_f32 v[84:85], v80
    v_mul_f32 v81, v32, v81
    v_cvt_f64_f32 v[86:87], v81
    v_mul_f32 v82, v32, v82
    v_cvt_f64_f32 v[88:89], v82
    v_mul_f32 v83, v32, v83
    v_cvt_f64_f32 v[90:91], v83
    ds_add_f64 v33, v[84:85] offset:512
    ds_add_f64 v33, v[86:87] offset:26112
    ds_add_f64 v34, v[88:89] offset:512
    ds_add_f64 v34, v[90:91] offset:26112
c_fbskip2:
    s_mov_b64 exec, -1
    v_bfe_u32 v76, v23, 6, 8
    v_cmpx_eq_u32 vcc, s35, v76
    s_cbranch_execz c_fbskip3
    buffer_load_dword v76, v16, s[8:11], s30 offen offset:12
    buffer_load_ushort v32, v12, s[20:23], s29 offen offset:6
    s_waitcnt vmcnt(1)
    v_lshlrev_b32 v76, 3, v76
    buffer_load_dwordx2 v[80:81], v76, s[16:19], 0 offen
    s_waitcnt vmcnt(1)
    v_lshlrev_b32 v32, 16, v32
    v_mul_f32 v32, s33, v32
    v_cvt_pk_bf16_f32 v32, 0, v32
    v_mul_f32 v33, 0x3e22f900, v32
    v_fract_f32 v33, v33
    v_fmamk_f32 v32, v32, 0x36036e4e, v33
    v_cos_f32 v32, v32
    v_lshrrev_b32 v33, 8, v23
    v_cvt_pk_bf16_f32 v32, 0, v32
    v_bfi_b32 v33, 63, v23, v33
    v_lshlrev_b32 v33, 3, v33
    v_add_u32 v34, 51200, v33
    s_waitcnt vmcnt(0)
    v_lshlrev_b32 v76, 16, v80
    v_and_b32 v77, 0xffff0000, v80
    v_lshlrev_b32 v78, 16, v81
    v_and_b32 v79, 0xffff0000, v81
    v_pk_mul_f32 v[80:81], v[76:77], s[64:65] op_sel:[0,0] op_sel_hi:[0,1]
    v_pk_fma_f32 v[80:81], v[76:77], s[68:69], v[80:81] op_sel:[1,0,0] op_sel_hi:[1,1,1]
    v_pk_fma_f32 v[80:81], v[78:79], s[72:73], v[80:81] op_sel:[0,0,0] op_sel_hi:[0,1,1]
    v_pk_fma_f32 v[80:81], v[78:79], s[76:77], v[80:81] op_sel:[1,0,0] op_sel_hi:[1,1,1]
    v_pk_mul_f32 v[82:83], v[76:77], s[66:67] op_sel:[0,0] op_sel_hi:[0,1]
    v_pk_fma_f32 v[82:83], v[76:77], s[70:71], v[82:83] op_sel:[1,0,0] op_sel_hi:[1,1,1]
    v_pk_fma_f32 v[82:83], v[78:79], s[74:75], v[82:83] op_sel:[0,0,0] op_sel_hi:[0,1,1]
    v_pk_fma_f32 v[82:83], v[78:79], s[78:79], v[82:83] op_sel:[1,0,0] op_sel_hi:[1,1,1]
    v_cvt_pk_bf16_f32 v80, 0, v80
    v_cvt_pk_bf16_f32 v81, 0, v81
    v_cvt_pk_bf16_f32 v82, 0, v82
    v_cvt_pk_bf16_f32 v83, 0, v83
    v_mul_f32 v80, v32, v80
    v_cvt_f64_f32 v[84:85], v80
    v_mul_f32 v81, v32, v81
    v_cvt_f64_f32 v[86:87], v81
    v_mul_f32 v82, v32, v82
    v_cvt_f64_f32 v[88:89], v82
    v_mul_f32 v83, v32, v83
    v_cvt_f64_f32 v[90:91], v83
    ds_add_f64 v33, v[84:85] offset:512
    ds_add_f64 v33, v[86:87] offset:26112
    ds_add_f64 v34, v[88:89] offset:512
    ds_add_f64 v34, v[90:91] offset:26112
c_fbskip3:
    s_mov_b64 exec, -1
    s_add_u32 s30, s30, 16384
    s_cmp_lt_u32 s30, 51200000
    s_cbranch_scc1 c_fbloop
    s_waitcnt lgkmcnt(0)
    s_barrier
    v_add_u32 v11, 51200, v12
    ds_read_b64 v[32:33], v12 offset:512
    ds_read_b64 v[34:35], v12 offset:26112
    ds_read_b64 v[36:37], v11 offset:512
    ds_read_b64 v[38:39], v11 offset:26112
    s_waitcnt lgkmcnt(0)
    v_cvt_f32_f64 v20, v[32:33]
    v_cvt_f32_f64 v21, v[34:35]
    v_cvt_f32_f64 v22, v[36:37]
    v_cvt_f32_f64 v23, v[38:39]
    v_pk_mul_f32 v[20:21], v[20:21], v[44:45]
    v_pk_mul_f32 v[22:23], v[22:23], v[46:47]
    v_cvt_pk_bf16_f32 v20, v20, v21
    v_cvt_pk_bf16_f32 v21, v22, v23
    s_nop 1
    v_mfma_f32_4x4x4_16b_bf16 v[76:79], v[120:121], v[20:21], 0
    s_nop 4
    v_cvt_pk_bf16_f32 v76, 0, v76
    v_cvt_pk_bf16_f32 v77, 0, v77
    v_cvt_pk_bf16_f32 v78, 0, v78
    v_cvt_pk_bf16_f32 v79, 0, v79
    v_pk_mul_f32 v[76:77], v[76:77], v[48:49]
    v_pk_mul_f32 v[78:79], v[78:79], v[50:51]
    v_cvt_pk_bf16_f32 v76, 0, v76
    v_cvt_pk_bf16_f32 v77, 0, v77
    v_cvt_pk_bf16_f32 v78, 0, v78
    v_cvt_pk_bf16_f32 v79, 0, v79
    v_pk_add_f32 v[76:77], v[76:77], v[96:97]
    v_pk_add_f32 v[78:79], v[78:79], v[98:99]
    v_cvt_pk_bf16_f32 v20, v76, v77
    v_cvt_pk_bf16_f32 v21, v78, v79
    s_add_u32 s31, s40, 0
    buffer_store_dwordx2 v[20:21], v10, s[24:27], s31 offen sc1
    s_nop 1
    ds_read_b64 v[32:33], v12 offset:8704
    ds_read_b64 v[34:35], v12 offset:34304
    ds_read_b64 v[36:37], v11 offset:8704
    ds_read_b64 v[38:39], v11 offset:34304
    s_waitcnt lgkmcnt(0)
    v_cvt_f32_f64 v20, v[32:33]
    v_cvt_f32_f64 v21, v[34:35]
    v_cvt_f32_f64 v22, v[36:37]
    v_cvt_f32_f64 v23, v[38:39]
    v_pk_mul_f32 v[20:21], v[20:21], v[52:53]
    v_pk_mul_f32 v[22:23], v[22:23], v[54:55]
    v_cvt_pk_bf16_f32 v20, v20, v21
    v_cvt_pk_bf16_f32 v21, v22, v23
    s_nop 1
    v_mfma_f32_4x4x4_16b_bf16 v[76:79], v[120:121], v[20:21], 0
    s_nop 4
    v_cvt_pk_bf16_f32 v76, 0, v76
    v_cvt_pk_bf16_f32 v77, 0, v77
    v_cvt_pk_bf16_f32 v78, 0, v78
    v_cvt_pk_bf16_f32 v79, 0, v79
    v_pk_mul_f32 v[76:77], v[76:77], v[56:57]
    v_pk_mul_f32 v[78:79], v[78:79], v[58:59]
    v_cvt_pk_bf16_f32 v76, 0, v76
    v_cvt_pk_bf16_f32 v77, 0, v77
    v_cvt_pk_bf16_f32 v78, 0, v78
    v_cvt_pk_bf16_f32 v79, 0, v79
    v_pk_add_f32 v[76:77], v[76:77], v[100:101]
    v_pk_add_f32 v[78:79], v[78:79], v[102:103]
    v_cvt_pk_bf16_f32 v20, v76, v77
    v_cvt_pk_bf16_f32 v21, v78, v79
    s_add_u32 s31, s40, 2097152
    buffer_store_dwordx2 v[20:21], v10, s[24:27], s31 offen sc1
    s_nop 1
    ds_read_b64 v[32:33], v12 offset:16896
    ds_read_b64 v[34:35], v12 offset:42496
    ds_read_b64 v[36:37], v11 offset:16896
    ds_read_b64 v[38:39], v11 offset:42496
    s_waitcnt lgkmcnt(0)
    v_cvt_f32_f64 v20, v[32:33]
    v_cvt_f32_f64 v21, v[34:35]
    v_cvt_f32_f64 v22, v[36:37]
    v_cvt_f32_f64 v23, v[38:39]
    v_pk_mul_f32 v[20:21], v[20:21], v[60:61]
    v_pk_mul_f32 v[22:23], v[22:23], v[62:63]
    v_cvt_pk_bf16_f32 v20, v20, v21
    v_cvt_pk_bf16_f32 v21, v22, v23
    s_nop 1
    v_mfma_f32_4x4x4_16b_bf16 v[76:79], v[120:121], v[20:21], 0
    s_nop 4
    v_cvt_pk_bf16_f32 v76, 0, v76
    v_cvt_pk_bf16_f32 v77, 0, v77
    v_cvt_pk_bf16_f32 v78, 0, v78
    v_cvt_pk_bf16_f32 v79, 0, v79
    v_pk_mul_f32 v[76:77], v[76:77], v[64:65]
    v_pk_mul_f32 v[78:79], v[78:79], v[66:67]
    v_cvt_pk_bf16_f32 v76, 0, v76
    v_cvt_pk_bf16_f32 v77, 0, v77
    v_cvt_pk_bf16_f32 v78, 0, v78
    v_cvt_pk_bf16_f32 v79, 0, v79
    v_pk_add_f32 v[76:77], v[76:77], v[104:105]
    v_pk_add_f32 v[78:79], v[78:79], v[106:107]
    v_cvt_pk_bf16_f32 v20, v76, v77
    v_cvt_pk_bf16_f32 v21, v78, v79
    s_add_u32 s31, s40, 4194304
    buffer_store_dwordx2 v[20:21], v10, s[24:27], s31 offen sc1
    s_nop 1
    s_cmp_lg_u32 s3, 0
    s_cbranch_scc1 f_done
    ds_read_b64 v[32:33], v12 offset:25088
    ds_read_b64 v[34:35], v12 offset:50688
    ds_read_b64 v[36:37], v11 offset:25088
    ds_read_b64 v[38:39], v11 offset:50688
    s_waitcnt lgkmcnt(0)
    v_cvt_f32_f64 v20, v[32:33]
    v_cvt_f32_f64 v21, v[34:35]
    v_cvt_f32_f64 v22, v[36:37]
    v_cvt_f32_f64 v23, v[38:39]
    v_pk_mul_f32 v[20:21], v[20:21], v[68:69]
    v_pk_mul_f32 v[22:23], v[22:23], v[70:71]
    v_cvt_pk_bf16_f32 v20, v20, v21
    v_cvt_pk_bf16_f32 v21, v22, v23
    s_nop 1
    v_mfma_f32_4x4x4_16b_bf16 v[76:79], v[120:121], v[20:21], 0
    s_nop 4
    v_cvt_pk_bf16_f32 v76, 0, v76
    v_cvt_pk_bf16_f32 v77, 0, v77
    v_cvt_pk_bf16_f32 v78, 0, v78
    v_cvt_pk_bf16_f32 v79, 0, v79
    v_pk_mul_f32 v[76:77], v[76:77], v[72:73]
    v_pk_mul_f32 v[78:79], v[78:79], v[74:75]
    v_cvt_pk_bf16_f32 v76, 0, v76
    v_cvt_pk_bf16_f32 v77, 0, v77
    v_cvt_pk_bf16_f32 v78, 0, v78
    v_cvt_pk_bf16_f32 v79, 0, v79
    v_pk_add_f32 v[76:77], v[76:77], v[108:109]
    v_pk_add_f32 v[78:79], v[78:79], v[110:111]
    v_cvt_pk_bf16_f32 v20, v76, v77
    v_cvt_pk_bf16_f32 v21, v78, v79
    s_add_u32 s31, s40, 6291456
    buffer_store_dwordx2 v[20:21], v10, s[24:27], s31 offen sc1
    s_nop 1
f_done:
    s_endpgm
.section .rodata,"a"
.p2align 6
.amdhsa_kernel standalone__molecular_angular_gemnet__graph_kernel
  .amdhsa_next_free_vgpr 127
  .amdhsa_next_free_sgpr 96
  .amdhsa_accum_offset 128
  .amdhsa_group_segment_fixed_size 0
  .amdhsa_kernarg_size 112
  .amdhsa_user_sgpr_count 2
  .amdhsa_user_sgpr_kernarg_segment_ptr 1
  .amdhsa_system_sgpr_workgroup_id_x 1
  .amdhsa_float_denorm_mode_32 3
.end_amdhsa_kernel
```
